```python
import torch

def _softmax(x, axis=-1):
    return torch.softmax(x, dim=axis)
def _gelu(x):
    return torch.nn.functional.gelu(x, approximate="tanh")
def _silu(x):
    return torch.nn.functional.silu(x)
def _sigmoid(x):
    return torch.sigmoid(x)
def _layernorm(x, axis=-1, eps=1e-5):
    m = x.mean(dim=axis, keepdim=True)
    v = x.var(dim=axis, keepdim=True, unbiased=False)
    return (x - m) / torch.sqrt(v + eps)
def _scatter_add(tgt, idx, src, axis=0):
    return tgt.clone().index_add_(axis, idx, src)
def _segment_sum(src, seg, n):
    out = torch.zeros((n,) + src.shape[1:], dtype=src.dtype)
    return out.index_add_(0, seg, src)
def _pad(x, pw):
    flat = tuple(v for pair in reversed(pw) for v in pair)
    return torch.nn.functional.pad(x, flat)

kernel_name = 'recurrent_scan__spectral_gfnet__geglu_ffn__prompt'

def setup_inputs():

    _w = (lambda a: (lambda t: t.to(torch.bfloat16) if t.is_floating_point() else t)(torch.as_tensor(a)))
    def _A_setup():
        B, S, D = 1, 2048, 512
        Df = D // 2 + 1
        return {
            "x": _w((lambda *s: torch.randn(*s, dtype=torch.bfloat16) * 0.05)(B, S, D)),
            "w_r": _w((lambda *s: torch.randn(*s, dtype=torch.bfloat16) * 0.1)(S, Df) * 0.02),
            "w_i": _w((lambda *s: torch.randn(*s, dtype=torch.bfloat16) * 0.1)(S, Df) * 0.02),
        }
    _A_in = _A_setup()

    def _B_setup():
        B, S, D, F = 1, 2048, 512, 1792
        return {
            "x": _w((lambda *s: torch.randn(*s, dtype=torch.bfloat16) * 0.05)(B, S, D)),
            "w_gate": _w((lambda *s: torch.randn(*s, dtype=torch.bfloat16) * 0.05)(D, F)),
            "w_up": _w((lambda *s: torch.randn(*s, dtype=torch.bfloat16) * 0.05)(D, F)),
            "w_down": _w((lambda *s: torch.randn(*s, dtype=torch.bfloat16) * 0.05)(F, D)),
        }
    _B_in = _B_setup()

    return {
        "A_x": _A_in["x"],
        "A_w_r": _A_in["w_r"],
        "A_w_i": _A_in["w_i"],
        "B_x": _B_in["x"],
        "B_w_gate": _B_in["w_gate"],
        "B_w_up": _B_in["w_up"],
        "B_w_down": _B_in["w_down"],
    }

def reference(A_x, A_w_r, A_w_i, B_x, B_w_gate, B_w_up, B_w_down):
    def _A_ref(x, w_r, w_i):
        B, S, D = x.shape
        X = (lambda x, axes=(-2,-1): torch.fft.rfft2(x.float(), dim=axes))(x, axes=(-2, -1))
        W = w_r + 1j * w_i
        X = X * W
        y = (lambda x, s, axes=(-2,-1): torch.fft.irfft2(x, s=s, dim=axes).to(torch.bfloat16))(X, (S, D), axes=(-2, -1))
        return y

    def _B_ref(x, w_gate, w_up, w_down):
        return (_gelu(x @ w_gate) * (x @ w_up)) @ w_down

    x = A_x
    xn = _layernorm(x, axis=-1)
    s = _A_ref(xn, A_w_r, A_w_i)
    g = _silu(_B_ref(xn, B_w_gate, B_w_up, B_w_down))
    return x + s * g
```

```asm
; @launch grid=(256,1,1) block=(512,1,1) lds=163840
.amdgcn_target "amdgcn-amd-amdhsa--gfx950"
.text
.globl recurrent_scan__spectral_gfnet__geglu_ffn__prompt_kernel
.p2align 8
.type recurrent_scan__spectral_gfnet__geglu_ffn__prompt_kernel,@function
recurrent_scan__spectral_gfnet__geglu_ffn__prompt_kernel:
s_cmp_ge_u32 s2, 256
s_cbranch_scc1 L_done
s_load_dwordx16 s[24:39], s[0:1], 0
s_load_dwordx4 s[40:43], s[0:1], 64
v_lshrrev_b32 v2, 6, v0
v_and_b32 v1, 63, v0
v_readfirstlane_b32 s20, v2
s_mov_b32 s21, s2
s_and_b32 s68, s2, 7
s_lshr_b32 s23, s2, 3
s_mov_b32 s67, 0
s_getpc_b64 s[60:61]
L_cph_1:
s_mul_i32 s59, s23, 1280
s_mul_i32 s57, s20, 160
s_add_u32 s59, s59, s57
v_and_b32 v112, 15, v1
v_lshl_add_u32 v112, v112, 4, s59
v_min_u32 v112, L_done - recurrent_scan__spectral_gfnet__geglu_ffn__prompt_kernel - 16, v112
s_add_u32 s60, s60, recurrent_scan__spectral_gfnet__geglu_ffn__prompt_kernel - L_cph_1
s_addc_u32 s61, s61, -1
v_mov_b32 v113, s61
v_add_co_u32 v112, vcc, s60, v112
    s_nop 1
v_addc_co_u32 v113, vcc, 0, v113, vcc
global_load_dwordx4 v[114:117], v[112:113], off
s_mul_i32 s44, s68, 28
s_add_u32 s44, s44, s23
s_and_b32 s64, s44, 7
s_lshr_b32 s65, s44, 3
s_mul_i32 s44, s65, 0
s_mul_i32 s45, s64, 1
s_add_u32 s44, s44, s45
s_and_b32 s2, s44, 7
s_lshr_b32 s44, s21, 2
s_and_b32 s45, s21, 3
s_lshr_b32 s46, s45, 1
s_lshl_b32 s46, s46, 4
s_and_b32 s47, s45, 1
s_lshl_b32 s47, s47, 2
s_add_u32 s46, s46, s47
s_lshr_b32 s47, s20, 2
s_lshl_b32 s47, s47, 3
s_add_u32 s46, s46, s47
s_and_b32 s47, s20, 3
s_add_u32 s46, s46, s47
s_lshl_b32 s46, s46, 6
s_add_u32 s46, s46, s44
s_lshl_b32 s56, s46, 10
v_lshlrev_b32 v2, 4, v1
s_waitcnt lgkmcnt(0)
s_mov_b32 s8, s24
s_and_b32 s9, s25, 0xffff
s_mov_b32 s10, 2097152
s_mov_b32 s11, 0x00020000
buffer_load_dwordx4 v[4:7], v2, s[8:11], s56 offen
s_load_dword s22, s[42:43], 0
s_mov_b32 s4, s42
s_and_b32 s5, s43, 0xffff
s_mov_b32 s6, 20971520
s_mov_b32 s7, 0x00020000
s_mov_b32 s12, s32
s_and_b32 s13, s33, 0xffff
s_mov_b32 s14, 1835008
s_mov_b32 s15, 0x00020000
s_mov_b32 s16, s34
s_and_b32 s17, s35, 0xffff
s_mov_b32 s18, 1835008
s_mov_b32 s19, 0x00020000
v_lshrrev_b32 v8, 3, v1
v_bfe_u32 v9, v1, 4, 1
v_lshlrev_b32 v9, 2, v9
v_and_b32 v10, 7, v1
v_xor_b32 v9, v9, v10
v_mul_u32_u24 v11, 3584, v8
v_lshl_add_u32 v146, v9, 4, v11
s_mul_i32 s47, s20, 28672
s_lshl_b32 s52, s65, 7
s_add_u32 s66, s47, s52
s_lshl_b32 s3, s20, 10
v_lshrrev_b32 v9, 2, v8
v_lshlrev_b32 v9, 3, v9
v_and_b32 v8, 3, v8
v_add_u32 v8, v8, v9
v_lshlrev_b32 v8, 10, v8
v_lshrrev_b32 v9, 4, v1
v_xor_b32 v9, v9, v10
v_lshl_add_u32 v147, v9, 4, v8
v_xor_b32 v148, 64, v147
s_lshl_b32 s47, s64, 3
s_add_u32 s47, s47, s20
s_lshl_b32 s58, s47, 15
v_and_b32 v30, 15, v1
v_lshrrev_b32 v29, 4, v1
v_cmp_eq_u32 s[62:63], 0, v30
v_cmp_gt_u32 vcc, 8, v30
v_cvt_f32_u32 v26, v30
v_cvt_f32_u32 v27, v29
v_mul_f32 v27, 4.0, v27
s_mov_b32 s47, 0
s_cmp_eq_u32 s20, 1
s_cbranch_scc1 L_c_4
s_cmp_eq_u32 s20, 2
s_cbranch_scc1 L_c_5
s_cmp_eq_u32 s20, 3
s_cbranch_scc1 L_c_6
s_cmp_eq_u32 s20, 4
s_cbranch_scc1 L_c_7
s_cmp_eq_u32 s20, 5
s_cbranch_scc1 L_c_8
s_cmp_eq_u32 s20, 6
s_cbranch_scc1 L_c_9
v_mul_f32 v20, 0x3d000000, v26
v_mov_b32 v22, 0
s_mov_b32 s47, 0x41800000
v_mov_b32 v21, v20
v_mov_b32 v23, 0
s_branch L_c_2
L_c_4:
v_mul_f32 v20, 0x3d000000, v26
v_mov_b32 v22, 0x3e800000
v_cndmask_b32 v20, v20, 0.5, s[62:63]
v_cndmask_b32 v22, v22, 0, s[62:63]
s_mov_b32 s47, 0x41800000
v_mov_b32 v21, v20
v_mov_b32 v23, v22
s_branch L_c_2
L_c_5:
v_mul_f32 v20, 0x3d800000, v26
v_mov_b32 v22, 0
v_mov_b32 v23, 0x3f400000
v_mov_b32 v21, v20
s_branch L_c_2
L_c_6:
v_mul_f32 v20, 0x3d800000, v26
v_cndmask_b32 v23, 0.5, 0, vcc
v_add_f32 v22, 0x3e800000, v23
v_mov_b32 v21, v20
s_branch L_c_2
L_c_7:
v_mul_f32 v20, 0x3d800000, v26
v_cndmask_b32 v21, v20, 0.5, s[62:63]
v_sub_f32 v24, 0x3f780000, v20
v_cndmask_b32 v20, 0, v21, vcc
v_cndmask_b32 v21, v24, 0, vcc
v_mov_b32 v24, 0x3e800000
v_cndmask_b32 v22, v24, 0, vcc
v_cndmask_b32 v23, 0, v24, vcc
s_branch L_c_2
L_c_8:
v_mul_f32 v20, 0x3d800000, v26
v_cndmask_b32 v21, v20, 0.5, s[62:63]
v_sub_f32 v24, 0x3f780000, v20
v_cndmask_b32 v20, 0, v21, vcc
v_cndmask_b32 v21, v24, 0, vcc
v_mov_b32 v22, 0x3e800000
v_mov_b32 v23, v22
s_branch L_c_2
L_c_9:
v_mul_f32 v20, 0x3b000000, v26
v_mov_b32 v22, 0
v_mov_b32 v23, 0x3f400000
v_mov_b32 v21, v20
L_c_2:
v_fma_f32 v22, v27, v20, v22
v_add_f32 v24, s47, v27
v_fma_f32 v23, v24, v21, v23
v_cos_f32 v32, v22
v_add_f32 v33, v22, v20
v_fma_f32 v34, v20, 2.0, v22
v_fmamk_f32 v35, v20, 0x40400000, v22
v_cos_f32 v33, v33
v_cos_f32 v34, v34
v_cos_f32 v35, v35
v_cos_f32 v36, v23
v_add_f32 v37, v23, v21
v_fma_f32 v38, v21, 2.0, v23
v_fmamk_f32 v39, v21, 0x40400000, v23
v_cos_f32 v37, v37
v_cos_f32 v38, v38
v_cos_f32 v39, v39
s_add_u32 s47, s3, 122880
v_add_u32 v24, s47, v2
s_cmp_eq_u32 s20, 6
s_cbranch_scc1 L_c6_10
s_cmp_eq_u32 s20, 7
s_cbranch_scc1 L_c7_11
v_cvt_pk_bf16_f32 v32, v32, v33
v_cvt_pk_bf16_f32 v33, v34, v35
v_cvt_pk_bf16_f32 v34, v36, v37
v_cvt_pk_bf16_f32 v35, v38, v39
ds_write_b128 v24, v[32:35]
s_branch L_c7_11
L_c6_10:
ds_write_b128 v24, v[32:35]
ds_write_b128 v24, v[36:39] offset:1024
L_c7_11:
s_add_u32 s61, s3, 114688
v_add_u32 v96, s61, v2
v_lshl_add_u32 v97, v1, 3, s61
v_add_u32 v108, 122880, v2
v_lshlrev_b32 v100, 11, v29
v_lshl_add_u32 v100, v30, 5, v100
s_lshl_b32 s61, s20, 1
s_add_u32 s61, s61, 98304
v_add_u32 v100, s61, v100
s_waitcnt lgkmcnt(0)
s_barrier
s_add_u32 s22, s22, 1013904223
ds_read_b128 v[64:67], v108 offset:0
ds_read_b128 v[68:71], v108 offset:1024
ds_read_b128 v[72:75], v108 offset:2048
ds_read_b128 v[76:79], v108 offset:3072
ds_read_b128 v[80:83], v108 offset:4096
ds_read_b128 v[84:87], v108 offset:5120
ds_read_b128 v[88:91], v108 offset:6144
ds_read_b128 v[92:95], v108 offset:7168
s_cmp_ge_u32 s23, 28
s_cbranch_scc1 L_bk_12
s_add_u32 s60, s2, 0
s_and_b32 s60, s60, 7
s_mul_i32 s60, s60, 229376
s_add_u32 s60, s60, s66
s_add_u32 m0, s3, 0
    s_nop 0
buffer_load_dwordx4 v146, s[12:15], s60 offen  lds
s_add_u32 m0, s3, 8192
    s_nop 0
buffer_load_dwordx4 v146, s[16:19], s60 offen  lds
L_bk_12:
s_cmp_lt_u32 s20, 4
s_cselect_b32 s96, s26, s28
s_cselect_b32 s97, s27, s29
s_and_b32 s97, s97, 0xffff
s_mov_b32 s98, 1052672
s_mov_b32 s99, 0x00020000
s_mul_i32 s53, s21, 4112
s_and_b32 s54, s20, 3
s_lshl_b32 s54, s54, 10
s_add_u32 s55, s53, s54
s_lshr_b32 s61, s20, 2
s_mul_i32 s61, s61, 4160
s_add_u32 s61, s61, 151552
s_add_u32 m0, s61, s54
    s_nop 0
buffer_load_dwordx4 v2, s[96:99], s55 offen  lds
s_add_u32 m0, s61, 4096
s_add_u32 s53, s53, 4096
s_mov_b64 exec, 1
buffer_load_dwordx4 v2, s[96:99], s53 offen  lds
s_mov_b64 exec, -1
v_lshlrev_b32 v101, 4, v0
v_add_u32 v101, 98304, v101
s_and_b32 s61, s44, 15
v_and_b32 v103, 15, v0
v_xor_b32 v102, s61, v103
v_lshlrev_b32 v102, 4, v102
v_lshrrev_b32 v12, 4, v0
v_lshl_add_u32 v102, v12, 16, v102
s_lshl_b32 s46, s21, 8
s_add_u32 s45, s46, 3145728
s_add_u32 s46, s46, 5242880
v_bfe_u32 v13, v0, 4, 4
v_and_b32 v12, 15, v0
v_lshlrev_b32 v14, 5, v13
v_add_u32 v20, v14, v12
v_sub_u32 v15, 0x200, v14
v_cmp_eq_u32 vcc, 0, v12
    s_nop 1
v_cndmask_b32 v21, v12, 16, vcc
v_sub_u32 v15, v15, v21
v_cmp_gt_u32 vcc, 8, v13
    s_nop 1
v_cndmask_b32 v20, v15, v20, vcc
v_and_b32 v12, 255, v0
v_mov_b32 v15, 0x100
v_cmp_eq_u32 vcc, 0, v12
    s_nop 1
v_cndmask_b32 v20, v20, v15, vcc
s_lshr_b32 s61, s20, 2
s_mul_i32 s60, s61, 2056
s_add_u32 s60, s60, 151552
v_lshl_add_u32 v127, v20, 1, s60
s_lshl_b32 s60, s21, 1
s_add_u32 s60, s60, s61
s_and_b32 s60, s60, 7
v_and_b32 v13, 7, v0
v_xor_b32 v13, s60, v13
v_lshlrev_b32 v13, 4, v13
v_lshrrev_b32 v12, 3, v12
v_lshl_add_u32 v103, v12, 16, v13
s_lshl_b32 s61, s61, 7
s_add_u32 s46, s46, s61
s_lshl_b32 s57, s21, 7
s_add_u32 s57, s57, 262144
v_lshlrev_b32 v126, 3, v1
v_and_b32 v13, 63, v126
v_add_u32 v99, 159872, v13
s_lshl_b32 s55, s21, 7
s_add_u32 s55, s55, 1048576
v_mov_b32 v3, v102
s_cmp_ge_u32 s23, 28
s_cbranch_scc1 L_wr_14
s_waitcnt vmcnt(4)
s_branch L_wr_15
L_wr_14:
s_waitcnt vmcnt(2)
L_wr_15:
v_lshlrev_b32 v32, 16, v4
v_and_b32 v33, 0xffff0000, v4
v_lshlrev_b32 v34, 16, v5
v_and_b32 v35, 0xffff0000, v5
v_lshlrev_b32 v36, 16, v6
v_and_b32 v37, 0xffff0000, v6
v_lshlrev_b32 v38, 16, v7
v_and_b32 v39, 0xffff0000, v7
v_pk_add_f32 v[40:41], v[32:33], v[34:35]
v_pk_add_f32 v[42:43], v[36:37], v[38:39]
v_pk_add_f32 v[40:41], v[40:41], v[42:43]
v_add_f32 v40, v40, v41
    s_nop 1
v_add_f32_dpp v40, v40, v40 row_shr:1 row_mask:0xf bank_mask:0xf
    s_nop 1
v_add_f32_dpp v40, v40, v40 row_shr:2 row_mask:0xf bank_mask:0xf
    s_nop 1
v_add_f32_dpp v40, v40, v40 row_shr:4 row_mask:0xf bank_mask:0xf
    s_nop 1
v_add_f32_dpp v40, v40, v40 row_shr:8 row_mask:0xf bank_mask:0xf
    s_nop 1
v_add_f32_dpp v40, v40, v40 row_bcast:15 row_mask:0xa bank_mask:0xf
    s_nop 1
v_add_f32_dpp v40, v40, v40 row_bcast:31 row_mask:0xc bank_mask:0xf
    s_nop 0
v_readlane_b32 s60, v40, 63
v_mov_b32 v41, 0x3b000000
    s_nop 0
v_mul_f32 v41, s60, v41
v_cvt_pk_bf16_f32 v42, v41, v41
v_sub_f32 v48, v32, v41
v_sub_f32 v49, v33, v41
v_sub_f32 v50, v34, v41
v_sub_f32 v51, v35, v41
v_sub_f32 v52, v36, v41
v_sub_f32 v53, v37, v41
v_sub_f32 v54, v38, v41
v_sub_f32 v55, v39, v41
v_lshlrev_b32 v42, 16, v42
v_mul_f32 v40, v48, v48
v_mul_f32 v43, v49, v49
v_fmac_f32 v40, v50, v50
v_fmac_f32 v43, v51, v51
v_fmac_f32 v40, v52, v52
v_fmac_f32 v43, v53, v53
v_fmac_f32 v40, v54, v54
v_fmac_f32 v43, v55, v55
v_add_f32 v40, v40, v43
v_sub_f32 v32, v32, v42
v_sub_f32 v33, v33, v42
v_add_f32_dpp v40, v40, v40 row_shr:1 row_mask:0xf bank_mask:0xf
v_sub_f32 v34, v34, v42
v_sub_f32 v35, v35, v42
v_add_f32_dpp v40, v40, v40 row_shr:2 row_mask:0xf bank_mask:0xf
v_sub_f32 v36, v36, v42
v_sub_f32 v37, v37, v42
v_add_f32_dpp v40, v40, v40 row_shr:4 row_mask:0xf bank_mask:0xf
v_sub_f32 v38, v38, v42
v_sub_f32 v39, v39, v42
v_add_f32_dpp v40, v40, v40 row_shr:8 row_mask:0xf bank_mask:0xf
v_cvt_pk_bf16_f32 v48, v32, v33
v_cvt_pk_bf16_f32 v49, v34, v35
v_add_f32_dpp v40, v40, v40 row_bcast:15 row_mask:0xa bank_mask:0xf
v_cvt_pk_bf16_f32 v50, v36, v37
v_cvt_pk_bf16_f32 v51, v38, v39
v_add_f32_dpp v40, v40, v40 row_bcast:31 row_mask:0xc bank_mask:0xf
v_mov_b32 v41, 0x3b000000
v_readlane_b32 s60, v40, 63
v_lshlrev_b32 v32, 16, v48
v_and_b32 v33, 0xffff0000, v48
v_lshlrev_b32 v34, 16, v49
v_and_b32 v35, 0xffff0000, v49
v_mul_f32 v41, s60, v41
v_cvt_pk_bf16_f32 v41, v41, v41
v_lshlrev_b32 v41, 16, v41
v_add_f32 v41, 0x3727c5ac, v41
v_cvt_pk_bf16_f32 v41, v41, v41
v_lshlrev_b32 v41, 16, v41
v_sqrt_f32 v41, v41
v_lshlrev_b32 v36, 16, v50
v_cvt_pk_bf16_f32 v41, v41, v41
v_lshlrev_b32 v41, 16, v41
v_rcp_f32 v41, v41
v_and_b32 v37, 0xffff0000, v50
v_lshlrev_b32 v38, 16, v51
v_and_b32 v39, 0xffff0000, v51
v_mul_f32 v32, v41, v32
v_mul_f32 v33, v41, v33
v_mul_f32 v34, v41, v34
v_mul_f32 v35, v41, v35
v_mul_f32 v36, v41, v36
v_mul_f32 v37, v41, v37
v_mul_f32 v38, v41, v38
v_mul_f32 v39, v41, v39
v_cvt_pk_bf16_f32 v4, v32, v33
v_cvt_pk_bf16_f32 v5, v34, v35
v_cvt_pk_bf16_f32 v6, v36, v37
v_cvt_pk_bf16_f32 v7, v38, v39
ds_write_b128 v96, v[4:7]
v_lshrrev_b32 v18, 16, v42
v_or_b32 v18, v18, v42
v_xor_b32 v18, 0x80008000, v18
v_mov_b32 v19, v41
s_lshl_b32 s61, s20, 3
s_add_u32 s61, s61, 159872
v_mov_b32 v14, s61
ds_write_b64 v14, v[18:19]
s_waitcnt lgkmcnt(0)
ds_read_b64_tr_b16 v[8:9], v97
ds_read_b64_tr_b16 v[10:11], v97 offset:512
s_waitcnt lgkmcnt(0)
v_mfma_f32_16x16x32_bf16 v[32:35], v[8:11], v[64:67], 0
v_mfma_f32_16x16x32_bf16 v[36:39], v[8:11], v[68:71], 0
    s_nop 6
v_pk_mul_f32 v[40:41], v[32:33], v[88:89]
v_pk_mul_f32 v[44:45], v[36:37], v[88:89]
v_pk_mul_f32 v[42:43], v[34:35], v[90:91]
v_pk_mul_f32 v[46:47], v[38:39], v[90:91]
v_pk_fma_f32 v[40:41], v[36:37], v[92:93], v[40:41]
v_pk_fma_f32 v[44:45], v[32:33], v[92:93], v[44:45] neg_lo:[1,0,0] neg_hi:[1,0,0]
v_pk_fma_f32 v[42:43], v[38:39], v[94:95], v[42:43]
v_pk_fma_f32 v[46:47], v[34:35], v[94:95], v[46:47] neg_lo:[1,0,0] neg_hi:[1,0,0]
v_cvt_pk_bf16_f32 v8, v40, v41
v_cvt_pk_bf16_f32 v9, v42, v43
v_cvt_pk_bf16_f32 v10, v44, v45
v_cvt_pk_bf16_f32 v11, v46, v47
    s_nop 1
v_mfma_f32_16x16x32_bf16 v[32:35], v[72:75], v[8:11], 0
v_mfma_f32_16x16x32_bf16 v[36:39], v[76:79], v[8:11], 0
v_mfma_f32_16x16x32_bf16 v[40:43], v[80:83], v[8:11], 0
v_mfma_f32_16x16x32_bf16 v[44:47], v[84:87], v[8:11], 0
    s_nop 6
v_cndmask_b32 v32, v32, v40, s[62:63]
v_cndmask_b32 v33, v33, v41, s[62:63]
v_cndmask_b32 v34, v34, v42, s[62:63]
v_cndmask_b32 v35, v35, v43, s[62:63]
v_cndmask_b32 v36, v36, v44, s[62:63]
v_cndmask_b32 v37, v37, v45, s[62:63]
v_cndmask_b32 v38, v38, v46, s[62:63]
v_cndmask_b32 v39, v39, v47, s[62:63]
v_cvt_pk_bf16_f32 v32, v32, v36
v_cvt_pk_bf16_f32 v33, v33, v37
v_cvt_pk_bf16_f32 v34, v34, v38
v_cvt_pk_bf16_f32 v35, v35, v39
ds_write_b16 v100, v32 offset:0
ds_write_b16_d16_hi v100, v32 offset:16
ds_write_b16 v100, v33 offset:512
ds_write_b16_d16_hi v100, v33 offset:528
ds_write_b16 v100, v34 offset:1024
ds_write_b16_d16_hi v100, v34 offset:1040
ds_write_b16 v100, v35 offset:1536
ds_write_b16_d16_hi v100, v35 offset:1552
s_mov_b32 s62, s46
s_mov_b32 s63, s55
v_mov_b32 v30, v127
v_mov_b32 v17, v126
v_mov_b32 v28, v103
s_cmp_ge_u32 s23, 28
s_cbranch_scc1 L_go_16
s_add_u32 s61, s2, 0
s_and_b32 s61, s61, 7
s_lshl_b32 s61, s61, 7
s_add_u32 s61, s61, s58
s_lshl_b32 s59, s3, 2
s_add_u32 m0, s59, 16384
    s_nop 0
buffer_load_dwordx4 v147, s[8:11], s61 offen  lds
s_add_u32 s61, s61, 4096
s_add_u32 m0, s59, 17408
    s_nop 0
buffer_load_dwordx4 v148, s[8:11], s61 offen  lds
s_add_u32 s61, s61, 12288
s_add_u32 m0, s59, 18432
    s_nop 0
buffer_load_dwordx4 v147, s[8:11], s61 offen  lds
s_add_u32 s61, s61, 4096
s_add_u32 m0, s59, 19456
    s_nop 0
buffer_load_dwordx4 v148, s[8:11], s61 offen  lds
L_go_16:
s_cmp_ge_u32 s23, 28
s_cbranch_scc1 L_wr_17
s_waitcnt vmcnt(4)
s_branch L_wr_18
L_wr_17:
s_waitcnt vmcnt(0)
L_wr_18:
s_waitcnt lgkmcnt(0)
s_barrier
ds_read_b128 v[20:23], v101
ds_read_b64 v[18:19], v99
ds_read_u16 v24, v30 offset:0
ds_read_u16 v4, v30 offset:4160
ds_read_u16 v25, v30 offset:514
ds_read_u16 v5, v30 offset:4674
ds_read_u16 v26, v30 offset:1028
ds_read_u16 v6, v30 offset:5188
ds_read_u16 v27, v30 offset:1542
ds_read_u16 v7, v30 offset:5702
s_waitcnt lgkmcnt(8)
buffer_store_dwordx4 v[20:23], v3, s[4:7], s45 offen sc1
s_cmp_lg_u32 s20, 0
s_cbranch_scc1 L_p0_st_19
s_mov_b64 exec, 0xffff
buffer_store_dwordx2 v[18:19], v17, s[4:7], s63 offen sc1
s_mov_b64 exec, -1
L_p0_st_19:
s_waitcnt lgkmcnt(0)
v_lshl_or_b32 v24, v4, 16, v24
v_lshl_or_b32 v25, v5, 16, v25
v_lshl_or_b32 v26, v6, 16, v26
v_lshl_or_b32 v27, v7, 16, v27
buffer_store_dwordx4 v[24:27], v28, s[4:7], s62 offen sc1
s_cmp_ge_u32 s23, 28
s_cbranch_scc1 L_cf
s_add_u32 s60, s2, 1
s_and_b32 s60, s60, 7
s_mul_i32 s60, s60, 229376
s_add_u32 s60, s60, s66
s_add_u32 m0, s3, 49152
    s_nop 0
buffer_load_dwordx4 v146, s[12:15], s60 offen  lds
s_add_u32 m0, s3, 57344
    s_nop 0
buffer_load_dwordx4 v146, s[16:19], s60 offen  lds
s_and_b32 s48, s20, 3
s_lshr_b32 s49, s20, 2
v_lshrrev_b32 v8, 5, v1
v_lshlrev_b32 v11, 3, v8
v_bfe_u32 v9, v1, 2, 2
v_add_u32 v11, v11, v9
v_lshlrev_b32 v11, 7, v11
v_and_b32 v10, 3, v1
v_lshl_add_u32 v11, v10, 3, v11
v_bfe_u32 v10, v1, 4, 1
v_lshl_add_u32 v11, v10, 5, v11
v_lshrrev_b32 v9, 1, v9
v_xor_b32 v9, s49, v9
v_lshl_add_u32 v12, v9, 6, v11
v_and_b32 v9, 31, v1
v_bfe_u32 v10, v1, 1, 3
v_xor_b32 v10, v10, v8
v_lshlrev_b32 v10, 4, v10
v_lshl_add_u32 v10, v9, 7, v10
s_lshl_b32 s50, s48, 13
s_add_u32 s50, s50, 16384
v_add_u32 v10, s50, v10
s_add_u32 s50, s48, 0
s_and_b32 s50, s50, 3
s_lshl_b32 s52, s50, 5
v_xor_b32 v212, s52, v10
s_lshl_b32 s52, s50, 11
v_add_u32 v208, s52, v12
s_add_u32 s50, s48, 1
s_and_b32 s50, s50, 3
s_lshl_b32 s52, s50, 5
v_xor_b32 v213, s52, v10
s_lshl_b32 s52, s50, 11
v_add_u32 v209, s52, v12
s_add_u32 s50, s48, 2
s_and_b32 s50, s50, 3
s_lshl_b32 s52, s50, 5
v_xor_b32 v214, s52, v10
s_lshl_b32 s52, s50, 11
v_add_u32 v210, s52, v12
s_add_u32 s50, s48, 3
s_and_b32 s50, s50, 3
s_lshl_b32 s52, s50, 5
v_xor_b32 v215, s52, v10
s_lshl_b32 s52, s50, 11
v_add_u32 v211, s52, v12
v_add_u32 v216, 49152, v208
v_add_u32 v217, 49152, v209
v_add_u32 v218, 49152, v210
v_add_u32 v219, 49152, v211
v_add_u32 v220, 49152, v212
v_add_u32 v221, 49152, v213
v_add_u32 v222, 49152, v214
v_add_u32 v223, 49152, v215
v_add_u32 v224, 98304, v208
v_add_u32 v225, 98304, v209
v_add_u32 v226, 98304, v210
v_add_u32 v227, 98304, v211
v_add_u32 v228, 98304, v212
v_add_u32 v229, 98304, v213
v_add_u32 v230, 98304, v214
v_add_u32 v231, 98304, v215
v_and_b32 v12, 15, v1
v_bfe_u32 v11, v1, 4, 1
v_mov_b32 v233, 0x3f803f80
v_cmp_eq_u32 vcc, v11, v12
    s_nop 1
v_cndmask_b32 v232, 0, v233, vcc
v_mov_b32 v233, v232
v_mov_b32 v234, v232
v_mov_b32 v235, v232
v_mov_b32 v128, 0
v_mov_b32 v129, 0
v_mov_b32 v130, 0
v_mov_b32 v131, 0
v_mov_b32 v132, 0
v_mov_b32 v133, 0
v_mov_b32 v134, 0
v_mov_b32 v135, 0
v_and_b32 v157, 15, v1
v_lshlrev_b32 v157, 4, v157
v_lshl_add_u32 v157, v8, 8, v157
v_bfe_u32 v11, v1, 4, 1
v_mul_u32_u24 v11, 57344, v11
v_add_u32 v157, v157, v11
s_lshl_b32 s50, s64, 3
s_lshl_b32 s51, s48, 1
s_add_u32 s50, s50, s51
s_mul_i32 s47, s50, 114688
s_lshl_b32 s52, s65, 11
s_add_u32 s47, s47, s52
s_lshl_b32 s52, s49, 10
s_add_u32 s47, s47, s52
s_add_u32 s47, s47, 10485760
s_lshr_b32 s51, s64, 2
s_lshl_b32 s51, s51, 1
s_and_b32 s52, s64, 1
s_add_u32 s51, s51, s52
s_lshl_b32 s51, s51, 7
s_add_u32 s51, s51, 262144
s_lshl_b32 s52, s20, 12
s_add_u32 s51, s51, s52
s_lshl_b32 s50, s64, 4
s_and_b32 s50, s50, 32
s_add_u32 s50, s50, s51
s_add_u32 s50, s50, 786432
v_and_b32 v149, 7, v1
v_lshlrev_b32 v149, 9, v149
v_bfe_u32 v153, v1, 1, 3
v_lshlrev_b32 v153, 9, v153
v_and_b32 v11, 1, v1
v_lshl_or_b32 v153, v11, 4, v153
v_and_b32 v154, 0x13, v9
v_bfe_u32 v11, v9, 2, 1
v_lshl_or_b32 v154, v11, 3, v154
v_bfe_u32 v11, v9, 3, 1
v_lshl_or_b32 v154, v11, 2, v154
s_lshl_b32 s52, s48, 3
s_add_u32 s52, s52, 160768
v_lshl_add_u32 v154, v154, 5, s52
s_lshl_b32 s52, s49, 11
s_add_u32 s52, s52, 147456
v_lshl_add_u32 v155, v9, 4, s52
s_lshl_b32 s52, s48, 2
v_add_u32 v156, s52, v155
s_waitcnt vmcnt(2)
s_barrier
s_cmp_lg_u32 s20, 0
s_cbranch_scc1 L_fl_20
v_mov_b32 v8, s22
v_lshlrev_b32 v9, 2, v1
s_mov_b32 exec_hi, 0
buffer_store_dword v8, v9, s[4:7], s57 offen sc1
s_mov_b64 exec, -1
L_fl_20:
s_add_u32 s61, s2, 1
s_and_b32 s61, s61, 7
s_lshl_b32 s61, s61, 7
s_add_u32 s61, s61, s58
s_lshl_b32 s59, s3, 2
s_add_u32 m0, s59, 65536
    s_nop 0
buffer_load_dwordx4 v147, s[8:11], s61 offen  lds
s_add_u32 s61, s61, 4096
s_add_u32 m0, s59, 66560
    s_nop 0
buffer_load_dwordx4 v148, s[8:11], s61 offen  lds
s_add_u32 s61, s61, 12288
s_add_u32 m0, s59, 67584
    s_nop 0
buffer_load_dwordx4 v147, s[8:11], s61 offen  lds
s_add_u32 s61, s61, 4096
s_add_u32 m0, s59, 68608
    s_nop 0
buffer_load_dwordx4 v148, s[8:11], s61 offen  lds
s_sub_u32 s57, s57, 258048
ds_read_b64_tr_b16 v[32:33], v208 offset:0
ds_read_b64_tr_b16 v[34:35], v208 offset:512
ds_read_b128 v[40:43], v212
ds_read_b64_tr_b16 v[36:37], v208 offset:8192
ds_read_b64_tr_b16 v[38:39], v208 offset:8704
ds_read_b128 v[44:47], v212 offset:4096
s_mov_b32 s96, s36
s_and_b32 s97, s37, 0xffff
s_mov_b32 s98, 1835008
s_mov_b32 s99, 0x00020000
s_lshl_b32 s100, s23, 16
s_lshl_b32 s101, s20, 13
s_add_u32 s100, s100, s101
v_and_b32 v159, 31, v1
v_lshlrev_b32 v159, 4, v159
v_lshrrev_b32 v158, 5, v1
v_lshl_add_u32 v159, v158, 10, v159
s_and_b32 s101, s68, 1
s_lshl_b32 s101, s101, 9
s_add_u32 s100, s100, s101
s_lshr_b32 s101, s68, 1
s_waitcnt lgkmcnt(3)
v_mfma_f32_32x32x16_bf16 v[64:79], v[32:35], v[40:43], 0
ds_read_b64_tr_b16 v[48:49], v209 offset:0
ds_read_b64_tr_b16 v[50:51], v209 offset:512
s_waitcnt lgkmcnt(3)
v_mfma_f32_32x32x16_bf16 v[80:95], v[36:39], v[40:43], 0
ds_read_b128 v[56:59], v213
ds_read_b64_tr_b16 v[52:53], v209 offset:8192
s_add_u32 s60, s2, 4
s_and_b32 s60, s60, 7
s_mul_i32 s60, s60, 229376
s_add_u32 s60, s60, s66
s_add_u32 m0, s3, 98304
    s_nop 0
buffer_load_dwordx4 v146, s[12:15], s60 offen  lds
v_mfma_f32_16x16x32_bf16 v[128:131], v[232:235], v[32:35], v[128:131]
s_waitcnt lgkmcnt(4)
v_mfma_f32_32x32x16_bf16 v[96:111], v[32:35], v[44:47], 0
ds_read_b64_tr_b16 v[54:55], v209 offset:8704
ds_read_b128 v[60:63], v213 offset:4096
s_add_u32 m0, s3, 106496
    s_nop 0
buffer_load_dwordx4 v146, s[16:19], s60 offen  lds
v_mfma_f32_32x32x16_bf16 v[112:127], v[36:39], v[44:47], 0
s_add_u32 s61, s2, 4
s_and_b32 s61, s61, 7
s_lshl_b32 s61, s61, 7
s_add_u32 s61, s61, s58
s_lshl_b32 s59, s3, 2
s_add_u32 m0, s59, 114688
    s_nop 0
buffer_load_dwordx4 v147, s[8:11], s61 offen  lds
v_mfma_f32_16x16x32_bf16 v[132:135], v[232:235], v[36:39], v[132:135]
s_waitcnt lgkmcnt(3)
v_mfma_f32_32x32x16_bf16 v[64:79], v[48:51], v[56:59], v[64:79]
ds_read_b64_tr_b16 v[32:33], v210 offset:0
ds_read_b64_tr_b16 v[34:35], v210 offset:512
s_waitcnt lgkmcnt(3)
v_mfma_f32_32x32x16_bf16 v[80:95], v[52:55], v[56:59], v[80:95]
ds_read_b128 v[40:43], v214
ds_read_b64_tr_b16 v[36:37], v210 offset:8192
s_add_u32 s61, s61, 4096
s_add_u32 m0, s59, 115712
    s_nop 0
buffer_load_dwordx4 v148, s[8:11], s61 offen  lds
s_waitcnt lgkmcnt(4)
v_mfma_f32_32x32x16_bf16 v[96:111], v[48:51], v[60:63], v[96:111]
ds_read_b64_tr_b16 v[38:39], v210 offset:8704
ds_read_b128 v[44:47], v214 offset:4096
v_mfma_f32_32x32x16_bf16 v[112:127], v[52:55], v[60:63], v[112:127]
s_waitcnt lgkmcnt(3)
v_mfma_f32_32x32x16_bf16 v[64:79], v[32:35], v[40:43], v[64:79]
ds_read_b64_tr_b16 v[48:49], v211 offset:0
ds_read_b64_tr_b16 v[50:51], v211 offset:512
s_waitcnt lgkmcnt(3)
v_mfma_f32_32x32x16_bf16 v[80:95], v[36:39], v[40:43], v[80:95]
ds_read_b128 v[56:59], v215
ds_read_b64_tr_b16 v[52:53], v211 offset:8192
s_add_u32 s61, s61, 12288
s_add_u32 m0, s59, 116736
    s_nop 0
buffer_load_dwordx4 v147, s[8:11], s61 offen  lds
s_waitcnt lgkmcnt(4)
v_mfma_f32_32x32x16_bf16 v[96:111], v[32:35], v[44:47], v[96:111]
ds_read_b64_tr_b16 v[54:55], v211 offset:8704
ds_read_b128 v[60:63], v215 offset:4096
v_mfma_f32_32x32x16_bf16 v[112:127], v[36:39], v[44:47], v[112:127]
s_waitcnt vmcnt(5) lgkmcnt(0)
s_barrier
v_mfma_f32_32x32x16_bf16 v[64:79], v[48:51], v[56:59], v[64:79]
ds_read_b64_tr_b16 v[32:33], v216 offset:0
ds_read_b64_tr_b16 v[34:35], v216 offset:512
v_mfma_f32_32x32x16_bf16 v[80:95], v[52:55], v[56:59], v[80:95]
ds_read_b128 v[40:43], v220
ds_read_b64_tr_b16 v[36:37], v216 offset:8192
s_add_u32 s61, s61, 4096
s_add_u32 m0, s59, 117760
    s_nop 0
buffer_load_dwordx4 v148, s[8:11], s61 offen  lds
v_mfma_f32_32x32x16_bf16 v[96:111], v[48:51], v[60:63], v[96:111]
ds_read_b64_tr_b16 v[38:39], v216 offset:8704
ds_read_b128 v[44:47], v220 offset:4096
v_mfma_f32_32x32x16_bf16 v[112:127], v[52:55], v[60:63], v[112:127]
s_waitcnt lgkmcnt(3)
v_mfma_f32_32x32x16_bf16 v[64:79], v[32:35], v[40:43], v[64:79]
ds_read_b64_tr_b16 v[48:49], v217 offset:0
ds_read_b64_tr_b16 v[50:51], v217 offset:512
s_waitcnt lgkmcnt(3)
v_mfma_f32_32x32x16_bf16 v[80:95], v[36:39], v[40:43], v[80:95]
ds_read_b128 v[56:59], v221
ds_read_b64_tr_b16 v[52:53], v217 offset:8192
s_add_u32 s60, s2, 5
s_and_b32 s60, s60, 7
s_mul_i32 s60, s60, 229376
s_add_u32 s60, s60, s66
s_add_u32 m0, s3, 0
    s_nop 0
buffer_load_dwordx4 v146, s[12:15], s60 offen  lds
v_mfma_f32_16x16x32_bf16 v[128:131], v[232:235], v[32:35], v[128:131]
s_waitcnt lgkmcnt(4)
v_mfma_f32_32x32x16_bf16 v[96:111], v[32:35], v[44:47], v[96:111]
ds_read_b64_tr_b16 v[54:55], v217 offset:8704
ds_read_b128 v[60:63], v221 offset:4096
s_add_u32 m0, s3, 8192
    s_nop 0
buffer_load_dwordx4 v146, s[16:19], s60 offen  lds
v_mfma_f32_32x32x16_bf16 v[112:127], v[36:39], v[44:47], v[112:127]
s_add_u32 s61, s2, 5
s_and_b32 s61, s61, 7
s_lshl_b32 s61, s61, 7
s_add_u32 s61, s61, s58
s_lshl_b32 s59, s3, 2
s_add_u32 m0, s59, 16384
    s_nop 0
buffer_load_dwordx4 v147, s[8:11], s61 offen  lds
v_mfma_f32_16x16x32_bf16 v[132:135], v[232:235], v[36:39], v[132:135]
s_waitcnt lgkmcnt(3)
v_mfma_f32_32x32x16_bf16 v[64:79], v[48:51], v[56:59], v[64:79]
ds_read_b64_tr_b16 v[32:33], v218 offset:0
ds_read_b64_tr_b16 v[34:35], v218 offset:512
s_waitcnt lgkmcnt(3)
v_mfma_f32_32x32x16_bf16 v[80:95], v[52:55], v[56:59], v[80:95]
ds_read_b128 v[40:43], v222
ds_read_b64_tr_b16 v[36:37], v218 offset:8192
s_add_u32 s61, s61, 4096
s_add_u32 m0, s59, 17408
    s_nop 0
buffer_load_dwordx4 v148, s[8:11], s61 offen  lds
s_waitcnt lgkmcnt(4)
v_mfma_f32_32x32x16_bf16 v[96:111], v[48:51], v[60:63], v[96:111]
ds_read_b64_tr_b16 v[38:39], v218 offset:8704
ds_read_b128 v[44:47], v222 offset:4096
v_mfma_f32_32x32x16_bf16 v[112:127], v[52:55], v[60:63], v[112:127]
s_waitcnt lgkmcnt(3)
v_mfma_f32_32x32x16_bf16 v[64:79], v[32:35], v[40:43], v[64:79]
ds_read_b64_tr_b16 v[48:49], v219 offset:0
ds_read_b64_tr_b16 v[50:51], v219 offset:512
s_waitcnt lgkmcnt(3)
v_mfma_f32_32x32x16_bf16 v[80:95], v[36:39], v[40:43], v[80:95]
ds_read_b128 v[56:59], v223
ds_read_b64_tr_b16 v[52:53], v219 offset:8192
s_add_u32 s61, s61, 12288
s_add_u32 m0, s59, 18432
    s_nop 0
buffer_load_dwordx4 v147, s[8:11], s61 offen  lds
s_waitcnt lgkmcnt(4)
v_mfma_f32_32x32x16_bf16 v[96:111], v[32:35], v[44:47], v[96:111]
ds_read_b64_tr_b16 v[54:55], v219 offset:8704
ds_read_b128 v[60:63], v223 offset:4096
v_mfma_f32_32x32x16_bf16 v[112:127], v[36:39], v[44:47], v[112:127]
s_waitcnt vmcnt(5) lgkmcnt(0)
s_barrier
v_mfma_f32_32x32x16_bf16 v[64:79], v[48:51], v[56:59], v[64:79]
ds_read_b64_tr_b16 v[32:33], v224 offset:0
ds_read_b64_tr_b16 v[34:35], v224 offset:512
v_mfma_f32_32x32x16_bf16 v[80:95], v[52:55], v[56:59], v[80:95]
ds_read_b128 v[40:43], v228
ds_read_b64_tr_b16 v[36:37], v224 offset:8192
s_add_u32 s61, s61, 4096
s_add_u32 m0, s59, 19456
    s_nop 0
buffer_load_dwordx4 v148, s[8:11], s61 offen  lds
v_mfma_f32_32x32x16_bf16 v[96:111], v[48:51], v[60:63], v[96:111]
ds_read_b64_tr_b16 v[38:39], v224 offset:8704
ds_read_b128 v[44:47], v228 offset:4096
v_mfma_f32_32x32x16_bf16 v[112:127], v[52:55], v[60:63], v[112:127]
s_waitcnt lgkmcnt(3)
v_mfma_f32_32x32x16_bf16 v[64:79], v[32:35], v[40:43], v[64:79]
ds_read_b64_tr_b16 v[48:49], v225 offset:0
ds_read_b64_tr_b16 v[50:51], v225 offset:512
s_waitcnt lgkmcnt(3)
v_mfma_f32_32x32x16_bf16 v[80:95], v[36:39], v[40:43], v[80:95]
ds_read_b128 v[56:59], v229
ds_read_b64_tr_b16 v[52:53], v225 offset:8192
s_add_u32 s60, s2, 2
s_and_b32 s60, s60, 7
s_mul_i32 s60, s60, 229376
s_add_u32 s60, s60, s66
s_add_u32 m0, s3, 49152
    s_nop 0
buffer_load_dwordx4 v146, s[12:15], s60 offen  lds
v_mfma_f32_16x16x32_bf16 v[128:131], v[232:235], v[32:35], v[128:131]
s_waitcnt lgkmcnt(4)
v_mfma_f32_32x32x16_bf16 v[96:111], v[32:35], v[44:47], v[96:111]
ds_read_b64_tr_b16 v[54:55], v225 offset:8704
ds_read_b128 v[60:63], v229 offset:4096
s_add_u32 m0, s3, 57344
    s_nop 0
buffer_load_dwordx4 v146, s[16:19], s60 offen  lds
v_mfma_f32_32x32x16_bf16 v[112:127], v[36:39], v[44:47], v[112:127]
s_add_u32 s61, s2, 2
s_and_b32 s61, s61, 7
s_lshl_b32 s61, s61, 7
s_add_u32 s61, s61, s58
s_lshl_b32 s59, s3, 2
s_add_u32 m0, s59, 65536
    s_nop 0
buffer_load_dwordx4 v147, s[8:11], s61 offen  lds
v_mfma_f32_16x16x32_bf16 v[132:135], v[232:235], v[36:39], v[132:135]
s_waitcnt lgkmcnt(3)
v_mfma_f32_32x32x16_bf16 v[64:79], v[48:51], v[56:59], v[64:79]
ds_read_b64_tr_b16 v[32:33], v226 offset:0
ds_read_b64_tr_b16 v[34:35], v226 offset:512
s_waitcnt lgkmcnt(3)
v_mfma_f32_32x32x16_bf16 v[80:95], v[52:55], v[56:59], v[80:95]
ds_read_b128 v[40:43], v230
ds_read_b64_tr_b16 v[36:37], v226 offset:8192
s_add_u32 s61, s61, 4096
s_add_u32 m0, s59, 66560
    s_nop 0
buffer_load_dwordx4 v148, s[8:11], s61 offen  lds
s_waitcnt lgkmcnt(4)
v_mfma_f32_32x32x16_bf16 v[96:111], v[48:51], v[60:63], v[96:111]
ds_read_b64_tr_b16 v[38:39], v226 offset:8704
ds_read_b128 v[44:47], v230 offset:4096
v_mfma_f32_32x32x16_bf16 v[112:127], v[52:55], v[60:63], v[112:127]
s_waitcnt lgkmcnt(3)
v_mfma_f32_32x32x16_bf16 v[64:79], v[32:35], v[40:43], v[64:79]
ds_read_b64_tr_b16 v[48:49], v227 offset:0
ds_read_b64_tr_b16 v[50:51], v227 offset:512
s_waitcnt lgkmcnt(3)
v_mfma_f32_32x32x16_bf16 v[80:95], v[36:39], v[40:43], v[80:95]
ds_read_b128 v[56:59], v231
ds_read_b64_tr_b16 v[52:53], v227 offset:8192
s_add_u32 s61, s61, 12288
s_add_u32 m0, s59, 67584
    s_nop 0
buffer_load_dwordx4 v147, s[8:11], s61 offen  lds
s_waitcnt lgkmcnt(4)
v_mfma_f32_32x32x16_bf16 v[96:111], v[32:35], v[44:47], v[96:111]
ds_read_b64_tr_b16 v[54:55], v227 offset:8704
ds_read_b128 v[60:63], v231 offset:4096
v_mfma_f32_32x32x16_bf16 v[112:127], v[36:39], v[44:47], v[112:127]
s_waitcnt vmcnt(5) lgkmcnt(0)
s_barrier
v_mfma_f32_32x32x16_bf16 v[64:79], v[48:51], v[56:59], v[64:79]
ds_read_b64_tr_b16 v[32:33], v208 offset:0
ds_read_b64_tr_b16 v[34:35], v208 offset:512
v_mfma_f32_32x32x16_bf16 v[80:95], v[52:55], v[56:59], v[80:95]
ds_read_b128 v[40:43], v212
ds_read_b64_tr_b16 v[36:37], v208 offset:8192
s_add_u32 s61, s61, 4096
s_add_u32 m0, s59, 68608
    s_nop 0
buffer_load_dwordx4 v148, s[8:11], s61 offen  lds
v_mfma_f32_32x32x16_bf16 v[96:111], v[48:51], v[60:63], v[96:111]
ds_read_b64_tr_b16 v[38:39], v208 offset:8704
ds_read_b128 v[44:47], v212 offset:4096
buffer_load_dword v16, v149, s[4:7], s51 offen sc1
v_mfma_f32_32x32x16_bf16 v[112:127], v[52:55], v[60:63], v[112:127]
s_waitcnt lgkmcnt(3)
v_mfma_f32_32x32x16_bf16 v[64:79], v[32:35], v[40:43], v[64:79]
ds_read_b64_tr_b16 v[48:49], v209 offset:0
ds_read_b64_tr_b16 v[50:51], v209 offset:512
s_waitcnt lgkmcnt(3)
v_mfma_f32_32x32x16_bf16 v[80:95], v[36:39], v[40:43], v[80:95]
ds_read_b128 v[56:59], v213
ds_read_b64_tr_b16 v[52:53], v209 offset:8192
s_add_u32 s60, s2, 3
s_and_b32 s60, s60, 7
s_mul_i32 s60, s60, 229376
s_add_u32 s60, s60, s66
s_add_u32 m0, s3, 98304
    s_nop 0
buffer_load_dwordx4 v146, s[12:15], s60 offen  lds
v_mfma_f32_16x16x32_bf16 v[128:131], v[232:235], v[32:35], v[128:131]
s_waitcnt lgkmcnt(4)
v_mfma_f32_32x32x16_bf16 v[96:111], v[32:35], v[44:47], v[96:111]
ds_read_b64_tr_b16 v[54:55], v209 offset:8704
ds_read_b128 v[60:63], v213 offset:4096
s_add_u32 m0, s3, 106496
    s_nop 0
buffer_load_dwordx4 v146, s[16:19], s60 offen  lds
v_mfma_f32_32x32x16_bf16 v[112:127], v[36:39], v[44:47], v[112:127]
s_add_u32 s61, s2, 3
s_and_b32 s61, s61, 7
s_lshl_b32 s61, s61, 7
s_add_u32 s61, s61, s58
s_lshl_b32 s59, s3, 2
s_add_u32 m0, s59, 114688
    s_nop 0
buffer_load_dwordx4 v147, s[8:11], s61 offen  lds
v_mfma_f32_16x16x32_bf16 v[132:135], v[232:235], v[36:39], v[132:135]
s_waitcnt lgkmcnt(3)
v_mfma_f32_32x32x16_bf16 v[64:79], v[48:51], v[56:59], v[64:79]
ds_read_b64_tr_b16 v[32:33], v210 offset:0
ds_read_b64_tr_b16 v[34:35], v210 offset:512
s_waitcnt lgkmcnt(3)
v_mfma_f32_32x32x16_bf16 v[80:95], v[52:55], v[56:59], v[80:95]
ds_read_b128 v[40:43], v214
ds_read_b64_tr_b16 v[36:37], v210 offset:8192
s_add_u32 s61, s61, 4096
s_add_u32 m0, s59, 115712
    s_nop 0
buffer_load_dwordx4 v148, s[8:11], s61 offen  lds
s_waitcnt lgkmcnt(4)
v_mfma_f32_32x32x16_bf16 v[96:111], v[48:51], v[60:63], v[96:111]
ds_read_b64_tr_b16 v[38:39], v210 offset:8704
ds_read_b128 v[44:47], v214 offset:4096
v_mfma_f32_32x32x16_bf16 v[112:127], v[52:55], v[60:63], v[112:127]
s_waitcnt lgkmcnt(3)
v_mfma_f32_32x32x16_bf16 v[64:79], v[32:35], v[40:43], v[64:79]
ds_read_b64_tr_b16 v[48:49], v211 offset:0
ds_read_b64_tr_b16 v[50:51], v211 offset:512
s_waitcnt lgkmcnt(3)
v_mfma_f32_32x32x16_bf16 v[80:95], v[36:39], v[40:43], v[80:95]
ds_read_b128 v[56:59], v215
ds_read_b64_tr_b16 v[52:53], v211 offset:8192
s_add_u32 s61, s61, 12288
s_add_u32 m0, s59, 116736
    s_nop 0
buffer_load_dwordx4 v147, s[8:11], s61 offen  lds
s_waitcnt lgkmcnt(4)
v_mfma_f32_32x32x16_bf16 v[96:111], v[32:35], v[44:47], v[96:111]
ds_read_b64_tr_b16 v[54:55], v211 offset:8704
ds_read_b128 v[60:63], v215 offset:4096
v_mfma_f32_32x32x16_bf16 v[112:127], v[36:39], v[44:47], v[112:127]
s_waitcnt vmcnt(5) lgkmcnt(0)
s_barrier
v_cmp_ne_u32 vcc, s22, v16
    s_nop 0
s_cmp_eq_u64 vcc, 0
s_cbranch_scc1 L_g1_ok_23
s_mov_b32 s69, 0
L_poll_24:
buffer_load_dword v16, v149, s[4:7], s51 offen sc1
s_waitcnt vmcnt(0)
v_xor_b32 v16, s22, v16
v_cmp_ne_u32 vcc, 0, v16
    s_nop 0
s_cmp_eq_u64 vcc, 0
s_cbranch_scc1 L_pollx_25
s_add_u32 s69, s69, 1
s_cmp_lt_u32 s69, 0x200000
s_cbranch_scc1 L_poll_24
L_pollx_25:
L_g1_ok_23:
s_lshl_b32 s52, s20, 8
s_add_u32 m0, s52, 160768
s_mov_b64 exec, 0xffff
buffer_load_dwordx4 v153, s[4:7], s50 offen sc1 lds
s_mov_b64 exec, -1
v_mfma_f32_32x32x16_bf16 v[64:79], v[48:51], v[56:59], v[64:79]
ds_read_b64_tr_b16 v[32:33], v216 offset:0
ds_read_b64_tr_b16 v[34:35], v216 offset:512
v_mfma_f32_32x32x16_bf16 v[80:95], v[52:55], v[56:59], v[80:95]
ds_read_b128 v[40:43], v220
ds_read_b64_tr_b16 v[36:37], v216 offset:8192
s_add_u32 s61, s61, 4096
s_add_u32 m0, s59, 117760
    s_nop 0
buffer_load_dwordx4 v148, s[8:11], s61 offen  lds
v_mfma_f32_32x32x16_bf16 v[96:111], v[48:51], v[60:63], v[96:111]
ds_read_b64_tr_b16 v[38:39], v216 offset:8704
ds_read_b128 v[44:47], v220 offset:4096
v_mfma_f32_32x32x16_bf16 v[112:127], v[52:55], v[60:63], v[112:127]
s_waitcnt lgkmcnt(3)
v_mfma_f32_32x32x16_bf16 v[64:79], v[32:35], v[40:43], v[64:79]
ds_read_b64_tr_b16 v[48:49], v217 offset:0
ds_read_b64_tr_b16 v[50:51], v217 offset:512
s_waitcnt lgkmcnt(3)
v_mfma_f32_32x32x16_bf16 v[80:95], v[36:39], v[40:43], v[80:95]
ds_read_b128 v[56:59], v221
ds_read_b64_tr_b16 v[52:53], v217 offset:8192
s_add_u32 s60, s2, 6
s_and_b32 s60, s60, 7
s_mul_i32 s60, s60, 229376
s_add_u32 s60, s60, s66
s_add_u32 m0, s3, 0
    s_nop 0
buffer_load_dwordx4 v146, s[12:15], s60 offen  lds
v_mfma_f32_16x16x32_bf16 v[128:131], v[232:235], v[32:35], v[128:131]
s_waitcnt lgkmcnt(4)
v_mfma_f32_32x32x16_bf16 v[96:111], v[32:35], v[44:47], v[96:111]
ds_read_b64_tr_b16 v[54:55], v217 offset:8704
ds_read_b128 v[60:63], v221 offset:4096
s_add_u32 m0, s3, 8192
    s_nop 0
buffer_load_dwordx4 v146, s[16:19], s60 offen  lds
v_mfma_f32_32x32x16_bf16 v[112:127], v[36:39], v[44:47], v[112:127]
s_add_u32 s61, s2, 6
s_and_b32 s61, s61, 7
s_lshl_b32 s61, s61, 7
s_add_u32 s61, s61, s58
s_lshl_b32 s59, s3, 2
s_add_u32 m0, s59, 16384
    s_nop 0
buffer_load_dwordx4 v147, s[8:11], s61 offen  lds
v_mfma_f32_16x16x32_bf16 v[132:135], v[232:235], v[36:39], v[132:135]
s_waitcnt lgkmcnt(3)
v_mfma_f32_32x32x16_bf16 v[64:79], v[48:51], v[56:59], v[64:79]
ds_read_b64_tr_b16 v[32:33], v218 offset:0
ds_read_b64_tr_b16 v[34:35], v218 offset:512
s_waitcnt lgkmcnt(3)
v_mfma_f32_32x32x16_bf16 v[80:95], v[52:55], v[56:59], v[80:95]
ds_read_b128 v[40:43], v222
ds_read_b64_tr_b16 v[36:37], v218 offset:8192
s_add_u32 s61, s61, 4096
s_add_u32 m0, s59, 17408
    s_nop 0
buffer_load_dwordx4 v148, s[8:11], s61 offen  lds
s_waitcnt lgkmcnt(4)
v_mfma_f32_32x32x16_bf16 v[96:111], v[48:51], v[60:63], v[96:111]
ds_read_b64_tr_b16 v[38:39], v218 offset:8704
ds_read_b128 v[44:47], v222 offset:4096
v_mfma_f32_32x32x16_bf16 v[112:127], v[52:55], v[60:63], v[112:127]
s_waitcnt lgkmcnt(3)
v_mfma_f32_32x32x16_bf16 v[64:79], v[32:35], v[40:43], v[64:79]
ds_read_b64_tr_b16 v[48:49], v219 offset:0
ds_read_b64_tr_b16 v[50:51], v219 offset:512
s_waitcnt lgkmcnt(3)
v_mfma_f32_32x32x16_bf16 v[80:95], v[36:39], v[40:43], v[80:95]
ds_read_b128 v[56:59], v223
ds_read_b64_tr_b16 v[52:53], v219 offset:8192
s_add_u32 s61, s61, 12288
s_add_u32 m0, s59, 18432
    s_nop 0
buffer_load_dwordx4 v147, s[8:11], s61 offen  lds
s_waitcnt lgkmcnt(4)
v_mfma_f32_32x32x16_bf16 v[96:111], v[32:35], v[44:47], v[96:111]
ds_read_b64_tr_b16 v[54:55], v219 offset:8704
ds_read_b128 v[60:63], v223 offset:4096
v_mfma_f32_32x32x16_bf16 v[112:127], v[36:39], v[44:47], v[112:127]
s_waitcnt vmcnt(5) lgkmcnt(0)
s_barrier
v_mfma_f32_32x32x16_bf16 v[64:79], v[48:51], v[56:59], v[64:79]
ds_read_b64_tr_b16 v[32:33], v224 offset:0
ds_read_b64_tr_b16 v[34:35], v224 offset:512
v_mfma_f32_32x32x16_bf16 v[80:95], v[52:55], v[56:59], v[80:95]
ds_read_b128 v[40:43], v228
ds_read_b64_tr_b16 v[36:37], v224 offset:8192
s_add_u32 s61, s61, 4096
s_add_u32 m0, s59, 19456
    s_nop 0
buffer_load_dwordx4 v148, s[8:11], s61 offen  lds
v_mfma_f32_32x32x16_bf16 v[96:111], v[48:51], v[60:63], v[96:111]
ds_read_b64_tr_b16 v[38:39], v224 offset:8704
ds_read_b128 v[44:47], v228 offset:4096
v_mfma_f32_32x32x16_bf16 v[112:127], v[52:55], v[60:63], v[112:127]
s_waitcnt lgkmcnt(3)
v_mfma_f32_32x32x16_bf16 v[64:79], v[32:35], v[40:43], v[64:79]
ds_read_b64_tr_b16 v[48:49], v225 offset:0
ds_read_b64_tr_b16 v[50:51], v225 offset:512
s_waitcnt lgkmcnt(3)
v_mfma_f32_32x32x16_bf16 v[80:95], v[36:39], v[40:43], v[80:95]
ds_read_b128 v[56:59], v229
ds_read_b64_tr_b16 v[52:53], v225 offset:8192
s_add_u32 s60, s2, 7
s_and_b32 s60, s60, 7
s_mul_i32 s60, s60, 229376
s_add_u32 s60, s60, s66
s_add_u32 m0, s3, 49152
    s_nop 0
buffer_load_dwordx4 v146, s[12:15], s60 offen  lds
v_mfma_f32_16x16x32_bf16 v[128:131], v[232:235], v[32:35], v[128:131]
s_waitcnt lgkmcnt(4)
v_mfma_f32_32x32x16_bf16 v[96:111], v[32:35], v[44:47], v[96:111]
ds_read_b64_tr_b16 v[54:55], v225 offset:8704
ds_read_b128 v[60:63], v229 offset:4096
s_add_u32 m0, s3, 57344
    s_nop 0
buffer_load_dwordx4 v146, s[16:19], s60 offen  lds
v_mfma_f32_32x32x16_bf16 v[112:127], v[36:39], v[44:47], v[112:127]
s_add_u32 s61, s2, 7
s_and_b32 s61, s61, 7
s_lshl_b32 s61, s61, 7
s_add_u32 s61, s61, s58
s_lshl_b32 s59, s3, 2
s_add_u32 m0, s59, 65536
    s_nop 0
buffer_load_dwordx4 v147, s[8:11], s61 offen  lds
v_mfma_f32_16x16x32_bf16 v[132:135], v[232:235], v[36:39], v[132:135]
s_waitcnt lgkmcnt(3)
v_mfma_f32_32x32x16_bf16 v[64:79], v[48:51], v[56:59], v[64:79]
ds_read_b64_tr_b16 v[32:33], v226 offset:0
ds_read_b64_tr_b16 v[34:35], v226 offset:512
s_waitcnt lgkmcnt(3)
v_mfma_f32_32x32x16_bf16 v[80:95], v[52:55], v[56:59], v[80:95]
ds_read_b128 v[40:43], v230
ds_read_b64_tr_b16 v[36:37], v226 offset:8192
s_add_u32 s61, s61, 4096
s_add_u32 m0, s59, 66560
    s_nop 0
buffer_load_dwordx4 v148, s[8:11], s61 offen  lds
s_waitcnt lgkmcnt(4)
v_mfma_f32_32x32x16_bf16 v[96:111], v[48:51], v[60:63], v[96:111]
ds_read_b64_tr_b16 v[38:39], v226 offset:8704
ds_read_b128 v[44:47], v230 offset:4096
v_mfma_f32_32x32x16_bf16 v[112:127], v[52:55], v[60:63], v[112:127]
s_waitcnt lgkmcnt(3)
v_mfma_f32_32x32x16_bf16 v[64:79], v[32:35], v[40:43], v[64:79]
ds_read_b64_tr_b16 v[48:49], v227 offset:0
ds_read_b64_tr_b16 v[50:51], v227 offset:512
s_waitcnt lgkmcnt(3)
v_mfma_f32_32x32x16_bf16 v[80:95], v[36:39], v[40:43], v[80:95]
ds_read_b128 v[56:59], v231
ds_read_b64_tr_b16 v[52:53], v227 offset:8192
s_add_u32 s61, s61, 12288
s_add_u32 m0, s59, 67584
    s_nop 0
buffer_load_dwordx4 v147, s[8:11], s61 offen  lds
s_waitcnt lgkmcnt(4)
v_mfma_f32_32x32x16_bf16 v[96:111], v[32:35], v[44:47], v[96:111]
ds_read_b64_tr_b16 v[54:55], v227 offset:8704
ds_read_b128 v[60:63], v231 offset:4096
v_mfma_f32_32x32x16_bf16 v[112:127], v[36:39], v[44:47], v[112:127]
s_waitcnt vmcnt(5) lgkmcnt(0)
s_barrier
v_mfma_f32_32x32x16_bf16 v[64:79], v[48:51], v[56:59], v[64:79]
ds_read_b64_tr_b16 v[32:33], v208 offset:0
ds_read_b64_tr_b16 v[34:35], v208 offset:512
v_mfma_f32_32x32x16_bf16 v[80:95], v[52:55], v[56:59], v[80:95]
ds_read_b128 v[40:43], v212
ds_read_b64_tr_b16 v[36:37], v208 offset:8192
s_add_u32 s61, s61, 4096
s_add_u32 m0, s59, 68608
    s_nop 0
buffer_load_dwordx4 v148, s[8:11], s61 offen  lds
v_mfma_f32_32x32x16_bf16 v[96:111], v[48:51], v[60:63], v[96:111]
ds_read_b64_tr_b16 v[38:39], v208 offset:8704
ds_read_b128 v[44:47], v212 offset:4096
v_mfma_f32_32x32x16_bf16 v[112:127], v[52:55], v[60:63], v[112:127]
s_waitcnt lgkmcnt(3)
v_mfma_f32_32x32x16_bf16 v[64:79], v[32:35], v[40:43], v[64:79]
ds_read_b64_tr_b16 v[48:49], v209 offset:0
ds_read_b64_tr_b16 v[50:51], v209 offset:512
s_lshr_b32 s44, s68, 1
s_lshl_b32 s44, s44, 3
s_and_b32 s45, s23, 7
s_add_u32 s44, s44, s45
s_and_b32 s45, s68, 1
s_lshl_b32 s45, s45, 2
s_lshr_b32 s46, s23, 3
s_add_u32 s45, s45, s46
s_and_b32 s48, s20, 3
s_lshr_b32 s49, s20, 2
s_lshl_b32 s50, s44, 2
s_add_u32 s50, s50, s48
s_mov_b32 s12, s36
s_and_b32 s13, s37, 0xffff
s_mov_b32 s14, 1835008
s_waitcnt lgkmcnt(3)
v_mfma_f32_32x32x16_bf16 v[80:95], v[36:39], v[40:43], v[80:95]
ds_read_b128 v[56:59], v213
ds_read_b64_tr_b16 v[52:53], v209 offset:8192
v_mfma_f32_16x16x32_bf16 v[128:131], v[232:235], v[32:35], v[128:131]
s_mov_b32 s15, 0x00020000
v_lshrrev_b32 v13, 3, v1
v_bfe_u32 v14, v1, 4, 2
v_lshlrev_b32 v14, 1, v14
v_and_b32 v15, 7, v1
v_xor_b32 v14, v14, v15
s_waitcnt lgkmcnt(4)
v_mfma_f32_32x32x16_bf16 v[96:111], v[32:35], v[44:47], v[96:111]
ds_read_b64_tr_b16 v[54:55], v209 offset:8704
ds_read_b128 v[60:63], v213 offset:4096
v_lshlrev_b32 v13, 10, v13
v_lshl_add_u32 v13, v14, 4, v13
s_lshl_b32 s46, s48, 15
s_lshl_b32 s51, s45, 7
s_add_u32 s51, s51, s46
s_mul_i32 s55, s49, 917504
s_add_u32 s51, s51, s55
s_lshl_b32 s46, s48, 12
s_lshl_b32 s55, s49, 14
s_add_u32 s55, s55, s46
v_lshrrev_b32 v14, 3, v1
s_add_u32 m0, s3, 152576
s_lshl_b32 s60, s101, 11
s_add_u32 s60, s60, s100
buffer_load_dwordx4 v159, s[96:99], s60 offen lds
s_add_u32 s101, s101, 1
s_and_b32 s101, s101, 3
v_mfma_f32_32x32x16_bf16 v[112:127], v[36:39], v[44:47], v[112:127]
v_mfma_f32_16x16x32_bf16 v[132:135], v[232:235], v[36:39], v[132:135]
v_and_b32 v244, 3, v14
v_lshrrev_b32 v14, 2, v14
v_lshl_or_b32 v244, v14, 3, v244
v_lshlrev_b32 v244, 10, v244
v_and_b32 v15, 7, v1
s_waitcnt lgkmcnt(3)
v_mfma_f32_32x32x16_bf16 v[64:79], v[48:51], v[56:59], v[64:79]
ds_read_b64_tr_b16 v[32:33], v210 offset:0
ds_read_b64_tr_b16 v[34:35], v210 offset:512
v_lshl_add_u32 v244, v15, 4, v244
s_and_b32 s56, s20, 6
s_lshl_b32 s56, s56, 3
s_and_b32 s46, s20, 1
s_lshl_b32 s46, s46, 2
s_add_u32 s56, s56, s46
s_lshl_b32 s46, s44, 6
s_add_u32 s56, s56, s46
s_lshl_b32 s56, s56, 10
s_lshl_b32 s46, s45, 7
s_add_u32 s56, s56, s46
s_waitcnt lgkmcnt(3)
v_mfma_f32_32x32x16_bf16 v[80:95], v[52:55], v[56:59], v[80:95]
ds_read_b128 v[40:43], v214
ds_read_b64_tr_b16 v[36:37], v210 offset:8192
s_waitcnt lgkmcnt(4)
v_mfma_f32_32x32x16_bf16 v[96:111], v[48:51], v[60:63], v[96:111]
ds_read_b64_tr_b16 v[38:39], v210 offset:8704
ds_read_b128 v[44:47], v214 offset:4096
v_mfma_f32_32x32x16_bf16 v[112:127], v[52:55], v[60:63], v[112:127]
s_waitcnt lgkmcnt(3)
v_mfma_f32_32x32x16_bf16 v[64:79], v[32:35], v[40:43], v[64:79]
ds_read_b64_tr_b16 v[48:49], v211 offset:0
ds_read_b64_tr_b16 v[50:51], v211 offset:512
s_waitcnt lgkmcnt(3)
v_mfma_f32_32x32x16_bf16 v[80:95], v[36:39], v[40:43], v[80:95]
ds_read_b128 v[56:59], v215
ds_read_b64_tr_b16 v[52:53], v211 offset:8192
s_waitcnt lgkmcnt(4)
v_mfma_f32_32x32x16_bf16 v[96:111], v[32:35], v[44:47], v[96:111]
ds_read_b64_tr_b16 v[54:55], v211 offset:8704
ds_read_b128 v[60:63], v215 offset:4096
s_add_u32 m0, s3, 152576
s_lshl_b32 s60, s101, 11
s_add_u32 s60, s60, s100
buffer_load_dwordx4 v159, s[96:99], s60 offen lds
s_add_u32 s101, s101, 1
s_and_b32 s101, s101, 3
v_mfma_f32_32x32x16_bf16 v[112:127], v[36:39], v[44:47], v[112:127]
s_waitcnt vmcnt(2) lgkmcnt(0)
s_barrier
ds_read_b64 v[150:151], v154
ds_read_b64 v[152:153], v154 offset:1024
v_mfma_f32_32x32x16_bf16 v[64:79], v[48:51], v[56:59], v[64:79]
ds_read_b64_tr_b16 v[32:33], v216 offset:0
ds_read_b64_tr_b16 v[34:35], v216 offset:512
v_mfma_f32_32x32x16_bf16 v[80:95], v[52:55], v[56:59], v[80:95]
ds_read_b128 v[40:43], v220
ds_read_b64_tr_b16 v[36:37], v216 offset:8192
v_mfma_f32_32x32x16_bf16 v[96:111], v[48:51], v[60:63], v[96:111]
ds_read_b64_tr_b16 v[38:39], v216 offset:8704
ds_read_b128 v[44:47], v220 offset:4096
v_mfma_f32_32x32x16_bf16 v[112:127], v[52:55], v[60:63], v[112:127]
s_waitcnt lgkmcnt(3)
v_mfma_f32_32x32x16_bf16 v[64:79], v[32:35], v[40:43], v[64:79]
ds_read_b64_tr_b16 v[48:49], v217 offset:0
ds_read_b64_tr_b16 v[50:51], v217 offset:512
v_cmp_gt_u32 vcc, 32, v1
s_nop 0
    s_nop 0
v_cndmask_b32 v150, 0, v150, vcc
v_mov_b32 v136, v150
v_mov_b32 v137, v150
v_mov_b32 v138, v150
s_waitcnt lgkmcnt(3)
v_mfma_f32_32x32x16_bf16 v[80:95], v[36:39], v[40:43], v[80:95]
ds_read_b128 v[56:59], v221
ds_read_b64_tr_b16 v[52:53], v217 offset:8192
v_mfma_f32_16x16x32_bf16 v[128:131], v[232:235], v[32:35], v[128:131]
v_mov_b32 v139, v150
v_mul_f32 v166, v151, v151
v_mul_f32 v162, 0xc0135761, v151
v_rcp_f32 v164, v166
v_mul_f32 v160, 0x3d372713, v166
s_waitcnt lgkmcnt(4)
v_mfma_f32_32x32x16_bf16 v[96:111], v[32:35], v[44:47], v[96:111]
ds_read_b64_tr_b16 v[54:55], v217 offset:8704
ds_read_b128 v[60:63], v221 offset:4096
v_mul_f32 v160, v160, v162
v_mov_b32 v163, v162
v_mov_b32 v165, v164
v_mov_b32 v161, v160
v_cmp_gt_u32 vcc, 32, v1
s_add_u32 m0, s3, 152576
s_lshl_b32 s60, s101, 11
s_add_u32 s60, s60, s100
buffer_load_dwordx4 v159, s[96:99], s60 offen lds
s_add_u32 s101, s101, 1
s_and_b32 s101, s101, 3
v_mfma_f32_32x32x16_bf16 v[112:127], v[36:39], v[44:47], v[112:127]
v_mfma_f32_16x16x32_bf16 v[132:135], v[232:235], v[36:39], v[132:135]
s_nop 0
v_cndmask_b32 v152, 0, v152, vcc
v_mov_b32 v140, v152
v_mov_b32 v141, v152
v_mov_b32 v142, v152
v_mov_b32 v143, v152
s_waitcnt lgkmcnt(3)
v_mfma_f32_32x32x16_bf16 v[64:79], v[48:51], v[56:59], v[64:79]
ds_read_b64_tr_b16 v[32:33], v218 offset:0
ds_read_b64_tr_b16 v[34:35], v218 offset:512
v_mul_f32 v174, v153, v153
v_mul_f32 v170, 0xc0135761, v153
v_rcp_f32 v172, v174
v_mul_f32 v168, 0x3d372713, v174
v_mul_f32 v168, v168, v170
s_waitcnt lgkmcnt(3)
v_mfma_f32_32x32x16_bf16 v[80:95], v[52:55], v[56:59], v[80:95]
ds_read_b128 v[40:43], v222
ds_read_b64_tr_b16 v[36:37], v218 offset:8192
v_mov_b32 v171, v170
v_mov_b32 v173, v172
v_mov_b32 v169, v168
s_waitcnt lgkmcnt(4)
v_mfma_f32_32x32x16_bf16 v[96:111], v[48:51], v[60:63], v[96:111]
ds_read_b64_tr_b16 v[38:39], v218 offset:8704
ds_read_b128 v[44:47], v222 offset:4096
v_mfma_f32_32x32x16_bf16 v[112:127], v[52:55], v[60:63], v[112:127]
s_waitcnt lgkmcnt(3)
v_mfma_f32_32x32x16_bf16 v[64:79], v[32:35], v[40:43], v[64:79]
ds_read_b64_tr_b16 v[48:49], v219 offset:0
ds_read_b64_tr_b16 v[50:51], v219 offset:512
v_cvt_pk_bf16_f32 v16, v128, v128
v_lshlrev_b32 v16, 16, v16
v_sub_f32 v16, v128, v16
v_cvt_pk_bf16_f32 v128, v128, v16
v_cvt_pk_bf16_f32 v16, v129, v129
s_waitcnt lgkmcnt(3)
v_mfma_f32_32x32x16_bf16 v[80:95], v[36:39], v[40:43], v[80:95]
ds_read_b128 v[56:59], v223
ds_read_b64_tr_b16 v[52:53], v219 offset:8192
v_lshlrev_b32 v16, 16, v16
v_sub_f32 v16, v129, v16
v_cvt_pk_bf16_f32 v129, v129, v16
v_cvt_pk_bf16_f32 v16, v132, v132
v_lshlrev_b32 v16, 16, v16
s_waitcnt lgkmcnt(4)
v_mfma_f32_32x32x16_bf16 v[96:111], v[32:35], v[44:47], v[96:111]
ds_read_b64_tr_b16 v[54:55], v219 offset:8704
ds_read_b128 v[60:63], v223 offset:4096
v_sub_f32 v16, v132, v16
v_cvt_pk_bf16_f32 v132, v132, v16
v_cvt_pk_bf16_f32 v16, v133, v133
v_lshlrev_b32 v16, 16, v16
v_sub_f32 v16, v133, v16
s_add_u32 m0, s3, 152576
s_lshl_b32 s60, s101, 11
s_add_u32 s60, s60, s100
buffer_load_dwordx4 v159, s[96:99], s60 offen lds
s_add_u32 s101, s101, 1
s_and_b32 s101, s101, 3
v_mfma_f32_32x32x16_bf16 v[112:127], v[36:39], v[44:47], v[112:127]
v_cvt_pk_bf16_f32 v133, v133, v16
s_waitcnt lgkmcnt(3)
v_mfma_f32_32x32x16_bf16 v[64:79], v[48:51], v[56:59], v[64:79]
s_waitcnt lgkmcnt(1)
v_mfma_f32_32x32x16_bf16 v[80:95], v[52:55], v[56:59], v[80:95]
s_waitcnt lgkmcnt(0)
v_mfma_f32_32x32x16_bf16 v[96:111], v[48:51], v[60:63], v[96:111]
v_mfma_f32_32x32x16_bf16 v[112:127], v[52:55], v[60:63], v[112:127]
s_mov_b64 exec, 0xffff
ds_write_b32 v156, v128
ds_write_b32 v156, v129 offset:256
ds_write_b32 v156, v132 offset:1024
ds_write_b32 v156, v133 offset:1280
s_mov_b64 exec, -1
s_waitcnt lgkmcnt(0)
s_barrier
ds_read_b128 v[32:35], v155
ds_read_b128 v[36:39], v155 offset:1024
s_waitcnt lgkmcnt(0)
v_mfma_f32_32x32x16_bf16 v[64:79], v[32:35], v[136:139], v[64:79]
v_mfma_f32_32x32x16_bf16 v[80:95], v[36:39], v[136:139], v[80:95]
v_mfma_f32_32x32x16_bf16 v[96:111], v[32:35], v[140:143], v[96:111]
v_mfma_f32_32x32x16_bf16 v[112:127], v[36:39], v[140:143], v[112:127]
    s_nop 8
v_pk_mul_f32 v[176:177], v[64:65], v[64:65]
v_pk_mul_f32 v[178:179], v[66:67], v[66:67]
v_pk_mul_f32 v[180:181], v[68:69], v[68:69]
v_pk_mul_f32 v[182:183], v[70:71], v[70:71]
v_pk_fma_f32 v[176:177], v[176:177], v[160:161], v[162:163]
v_pk_fma_f32 v[178:179], v[178:179], v[160:161], v[162:163]
v_pk_fma_f32 v[180:181], v[180:181], v[160:161], v[162:163]
v_pk_fma_f32 v[182:183], v[182:183], v[160:161], v[162:163]
v_pk_mul_f32 v[176:177], v[176:177], v[64:65]
v_pk_mul_f32 v[178:179], v[178:179], v[66:67]
v_pk_mul_f32 v[180:181], v[180:181], v[68:69]
v_pk_mul_f32 v[182:183], v[182:183], v[70:71]
v_exp_f32 v176, v176
v_exp_f32 v177, v177
v_exp_f32 v178, v178
v_exp_f32 v179, v179
v_exp_f32 v180, v180
v_exp_f32 v181, v181
v_exp_f32 v182, v182
v_exp_f32 v183, v183
v_pk_mul_f32 v[184:185], v[64:65], v[80:81]
v_pk_mul_f32 v[186:187], v[66:67], v[82:83]
v_pk_mul_f32 v[188:189], v[68:69], v[84:85]
v_pk_mul_f32 v[190:191], v[70:71], v[86:87]
v_pk_fma_f32 v[176:177], v[176:177], v[164:165], v[164:165]
v_pk_fma_f32 v[178:179], v[178:179], v[164:165], v[164:165]
v_pk_fma_f32 v[180:181], v[180:181], v[164:165], v[164:165]
v_pk_fma_f32 v[182:183], v[182:183], v[164:165], v[164:165]
v_rcp_f32 v176, v176
v_rcp_f32 v177, v177
v_rcp_f32 v178, v178
v_rcp_f32 v179, v179
v_rcp_f32 v180, v180
v_rcp_f32 v181, v181
v_rcp_f32 v182, v182
v_rcp_f32 v183, v183
v_pk_mul_f32 v[176:177], v[176:177], v[184:185]
v_pk_mul_f32 v[178:179], v[178:179], v[186:187]
v_pk_mul_f32 v[180:181], v[180:181], v[188:189]
v_pk_mul_f32 v[182:183], v[182:183], v[190:191]
v_cvt_pk_bf16_f32 v184, v176, v177
v_cvt_pk_bf16_f32 v185, v178, v179
v_cvt_pk_bf16_f32 v186, v180, v181
v_cvt_pk_bf16_f32 v187, v182, v183
buffer_store_dwordx4 v[184:187], v157, s[4:7], s47 offen offset:0 sc1
v_pk_mul_f32 v[192:193], v[72:73], v[72:73]
v_pk_mul_f32 v[194:195], v[74:75], v[74:75]
v_pk_mul_f32 v[196:197], v[76:77], v[76:77]
v_pk_mul_f32 v[198:199], v[78:79], v[78:79]
v_pk_fma_f32 v[192:193], v[192:193], v[160:161], v[162:163]
v_pk_fma_f32 v[194:195], v[194:195], v[160:161], v[162:163]
v_pk_fma_f32 v[196:197], v[196:197], v[160:161], v[162:163]
v_pk_fma_f32 v[198:199], v[198:199], v[160:161], v[162:163]
v_pk_mul_f32 v[192:193], v[192:193], v[72:73]
v_pk_mul_f32 v[194:195], v[194:195], v[74:75]
v_pk_mul_f32 v[196:197], v[196:197], v[76:77]
v_pk_mul_f32 v[198:199], v[198:199], v[78:79]
v_exp_f32 v192, v192
v_exp_f32 v193, v193
v_exp_f32 v194, v194
v_exp_f32 v195, v195
v_exp_f32 v196, v196
v_exp_f32 v197, v197
v_exp_f32 v198, v198
v_exp_f32 v199, v199
v_pk_mul_f32 v[200:201], v[72:73], v[88:89]
v_pk_mul_f32 v[202:203], v[74:75], v[90:91]
v_pk_mul_f32 v[204:205], v[76:77], v[92:93]
v_pk_mul_f32 v[206:207], v[78:79], v[94:95]
v_pk_fma_f32 v[192:193], v[192:193], v[164:165], v[164:165]
v_pk_fma_f32 v[194:195], v[194:195], v[164:165], v[164:165]
v_pk_fma_f32 v[196:197], v[196:197], v[164:165], v[164:165]
v_pk_fma_f32 v[198:199], v[198:199], v[164:165], v[164:165]
v_rcp_f32 v192, v192
v_rcp_f32 v193, v193
v_rcp_f32 v194, v194
v_rcp_f32 v195, v195
v_rcp_f32 v196, v196
v_rcp_f32 v197, v197
v_rcp_f32 v198, v198
v_rcp_f32 v199, v199
v_pk_mul_f32 v[192:193], v[192:193], v[200:201]
v_pk_mul_f32 v[194:195], v[194:195], v[202:203]
v_pk_mul_f32 v[196:197], v[196:197], v[204:205]
v_pk_mul_f32 v[198:199], v[198:199], v[206:207]
v_cvt_pk_bf16_f32 v200, v192, v193
v_cvt_pk_bf16_f32 v201, v194, v195
v_cvt_pk_bf16_f32 v202, v196, v197
v_cvt_pk_bf16_f32 v203, v198, v199
buffer_store_dwordx4 v[200:203], v157, s[4:7], s47 offen offset:512 sc1
v_pk_mul_f32 v[176:177], v[96:97], v[96:97]
v_pk_mul_f32 v[178:179], v[98:99], v[98:99]
v_pk_mul_f32 v[180:181], v[100:101], v[100:101]
v_pk_mul_f32 v[182:183], v[102:103], v[102:103]
v_pk_fma_f32 v[176:177], v[176:177], v[168:169], v[170:171]
v_pk_fma_f32 v[178:179], v[178:179], v[168:169], v[170:171]
v_pk_fma_f32 v[180:181], v[180:181], v[168:169], v[170:171]
v_pk_fma_f32 v[182:183], v[182:183], v[168:169], v[170:171]
v_pk_mul_f32 v[176:177], v[176:177], v[96:97]
v_pk_mul_f32 v[178:179], v[178:179], v[98:99]
v_pk_mul_f32 v[180:181], v[180:181], v[100:101]
v_pk_mul_f32 v[182:183], v[182:183], v[102:103]
v_exp_f32 v176, v176
v_exp_f32 v177, v177
v_exp_f32 v178, v178
v_exp_f32 v179, v179
v_exp_f32 v180, v180
v_exp_f32 v181, v181
v_exp_f32 v182, v182
v_exp_f32 v183, v183
v_pk_mul_f32 v[184:185], v[96:97], v[112:113]
v_pk_mul_f32 v[186:187], v[98:99], v[114:115]
v_pk_mul_f32 v[188:189], v[100:101], v[116:117]
v_pk_mul_f32 v[190:191], v[102:103], v[118:119]
v_pk_fma_f32 v[176:177], v[176:177], v[172:173], v[172:173]
v_pk_fma_f32 v[178:179], v[178:179], v[172:173], v[172:173]
v_pk_fma_f32 v[180:181], v[180:181], v[172:173], v[172:173]
v_pk_fma_f32 v[182:183], v[182:183], v[172:173], v[172:173]
v_rcp_f32 v176, v176
v_rcp_f32 v177, v177
v_rcp_f32 v178, v178
v_rcp_f32 v179, v179
v_rcp_f32 v180, v180
v_rcp_f32 v181, v181
v_rcp_f32 v182, v182
v_rcp_f32 v183, v183
v_pk_mul_f32 v[176:177], v[176:177], v[184:185]
v_pk_mul_f32 v[178:179], v[178:179], v[186:187]
v_pk_mul_f32 v[180:181], v[180:181], v[188:189]
v_pk_mul_f32 v[182:183], v[182:183], v[190:191]
v_cvt_pk_bf16_f32 v184, v176, v177
v_cvt_pk_bf16_f32 v185, v178, v179
v_cvt_pk_bf16_f32 v186, v180, v181
v_cvt_pk_bf16_f32 v187, v182, v183
s_add_u32 s47, s47, 114688
buffer_store_dwordx4 v[184:187], v157, s[4:7], s47 offen offset:0 sc1
v_pk_mul_f32 v[192:193], v[104:105], v[104:105]
v_pk_mul_f32 v[194:195], v[106:107], v[106:107]
v_pk_mul_f32 v[196:197], v[108:109], v[108:109]
v_pk_mul_f32 v[198:199], v[110:111], v[110:111]
v_pk_fma_f32 v[192:193], v[192:193], v[168:169], v[170:171]
v_pk_fma_f32 v[194:195], v[194:195], v[168:169], v[170:171]
v_pk_fma_f32 v[196:197], v[196:197], v[168:169], v[170:171]
v_pk_fma_f32 v[198:199], v[198:199], v[168:169], v[170:171]
v_pk_mul_f32 v[192:193], v[192:193], v[104:105]
v_pk_mul_f32 v[194:195], v[194:195], v[106:107]
v_pk_mul_f32 v[196:197], v[196:197], v[108:109]
v_pk_mul_f32 v[198:199], v[198:199], v[110:111]
v_exp_f32 v192, v192
v_exp_f32 v193, v193
v_exp_f32 v194, v194
v_exp_f32 v195, v195
v_exp_f32 v196, v196
v_exp_f32 v197, v197
v_exp_f32 v198, v198
v_exp_f32 v199, v199
v_pk_mul_f32 v[200:201], v[104:105], v[120:121]
v_pk_mul_f32 v[202:203], v[106:107], v[122:123]
v_pk_mul_f32 v[204:205], v[108:109], v[124:125]
v_pk_mul_f32 v[206:207], v[110:111], v[126:127]
v_pk_fma_f32 v[192:193], v[192:193], v[172:173], v[172:173]
v_pk_fma_f32 v[194:195], v[194:195], v[172:173], v[172:173]
v_pk_fma_f32 v[196:197], v[196:197], v[172:173], v[172:173]
v_pk_fma_f32 v[198:199], v[198:199], v[172:173], v[172:173]
v_rcp_f32 v192, v192
v_rcp_f32 v193, v193
v_rcp_f32 v194, v194
v_rcp_f32 v195, v195
v_rcp_f32 v196, v196
v_rcp_f32 v197, v197
v_rcp_f32 v198, v198
v_rcp_f32 v199, v199
v_pk_mul_f32 v[192:193], v[192:193], v[200:201]
v_pk_mul_f32 v[194:195], v[194:195], v[202:203]
v_pk_mul_f32 v[196:197], v[196:197], v[204:205]
v_pk_mul_f32 v[198:199], v[198:199], v[206:207]
v_cvt_pk_bf16_f32 v200, v192, v193
v_cvt_pk_bf16_f32 v201, v194, v195
v_cvt_pk_bf16_f32 v202, v196, v197
v_cvt_pk_bf16_f32 v203, v198, v199
buffer_store_dwordx4 v[200:203], v157, s[4:7], s47 offen offset:512 sc1
s_waitcnt vmcnt(0)
s_barrier
s_lshl_b32 s57, s64, 5
s_add_u32 s57, s57, s65
s_lshl_b32 s57, s57, 7
s_add_u32 s57, s57, 69632
s_cmp_lg_u32 s20, 0
s_cbranch_scc1 L_fl_26
v_mov_b32 v16, s22
v_lshlrev_b32 v17, 2, v1
s_mov_b32 exec_hi, 0
buffer_store_dword v16, v17, s[4:7], s57 offen sc1
s_mov_b64 exec, -1
L_fl_26:
s_add_u32 m0, s55, 0
s_add_u32 s52, s51, 0
buffer_load_dwordx4 v13, s[12:15], s52 offen lds
s_add_u32 m0, s55, 1024
s_add_u32 s52, s51, 8192
buffer_load_dwordx4 v13, s[12:15], s52 offen lds
s_add_u32 m0, s55, 2048
s_add_u32 s52, s51, 16384
buffer_load_dwordx4 v13, s[12:15], s52 offen lds
s_add_u32 m0, s55, 3072
s_add_u32 s52, s51, 24576
buffer_load_dwordx4 v13, s[12:15], s52 offen lds
s_add_u32 m0, s55, 32768
s_add_u32 s52, s51, 131072
buffer_load_dwordx4 v13, s[12:15], s52 offen lds
s_add_u32 m0, s55, 33792
s_add_u32 s52, s51, 139264
buffer_load_dwordx4 v13, s[12:15], s52 offen lds
s_add_u32 m0, s55, 34816
s_add_u32 s52, s51, 147456
buffer_load_dwordx4 v13, s[12:15], s52 offen lds
s_add_u32 m0, s55, 35840
s_add_u32 s52, s51, 155648
buffer_load_dwordx4 v13, s[12:15], s52 offen lds
s_add_u32 m0, s55, 65536
s_add_u32 s52, s51, 262144
buffer_load_dwordx4 v13, s[12:15], s52 offen lds
s_add_u32 m0, s55, 66560
s_add_u32 s52, s51, 270336
buffer_load_dwordx4 v13, s[12:15], s52 offen lds
s_add_u32 m0, s55, 67584
s_add_u32 s52, s51, 278528
buffer_load_dwordx4 v13, s[12:15], s52 offen lds
s_add_u32 m0, s55, 68608
s_add_u32 s52, s51, 286720
buffer_load_dwordx4 v13, s[12:15], s52 offen lds
s_add_u32 m0, s55, 98304
s_add_u32 s52, s51, 393216
buffer_load_dwordx4 v13, s[12:15], s52 offen lds
s_add_u32 m0, s55, 99328
s_add_u32 s52, s51, 401408
buffer_load_dwordx4 v13, s[12:15], s52 offen lds
s_add_u32 m0, s55, 100352
s_add_u32 s52, s51, 409600
buffer_load_dwordx4 v13, s[12:15], s52 offen lds
s_add_u32 m0, s55, 101376
s_add_u32 s52, s51, 417792
buffer_load_dwordx4 v13, s[12:15], s52 offen lds
s_add_u32 m0, s55, 131072
s_add_u32 s52, s51, 524288
buffer_load_dwordx4 v13, s[12:15], s52 offen lds
s_add_u32 m0, s55, 132096
s_add_u32 s52, s51, 532480
buffer_load_dwordx4 v13, s[12:15], s52 offen lds
s_add_u32 m0, s55, 133120
s_add_u32 s52, s51, 540672
buffer_load_dwordx4 v13, s[12:15], s52 offen lds
s_add_u32 m0, s55, 134144
s_add_u32 s52, s51, 548864
buffer_load_dwordx4 v13, s[12:15], s52 offen lds
s_branch L_g2
L_cf:
s_lshl_b32 s44, s68, 2
s_add_u32 s44, s44, s23
s_sub_u32 s44, s44, 28
s_lshr_b32 s46, s44, 1
s_lshl_b32 s47, s46, 5
s_and_b32 s49, s44, 1
s_lshl_b32 s49, s49, 3
s_add_u32 s47, s47, s49
s_sub_u32 s48, 0x200, s47
s_cmp_lt_u32 s46, 8
s_cselect_b32 s47, s47, s48
s_cselect_b32 s50, 1.0, -1.0
s_cselect_b32 s51, 0, 16
s_cmp_eq_u32 s49, 0
s_cselect_b32 s51, s51, 0
s_sub_u32 s51, s47, s51
s_cmp_eq_u32 s44, 0
s_cselect_b32 s51, 0x100, s51
s_mov_b32 s52, 0x36000000
s_cselect_b32 s53, 0x35800000, s52
v_cvt_f32_u32 v8, v0
v_mul_f32 v8, 0x3b000000, v8
v_cvt_f32_u32 v9, s47
v_cvt_f32_u32 v10, s51
v_mul_f32 v9, v9, v8
v_mul_f32 v64, v10, v8
v_mul_f32 v8, s50, v8
v_fract_f32 v9, v9
v_fract_f32 v64, v64
v_fmamk_f32 v65, v8, 0x3f800000, v9
v_fmamk_f32 v66, v8, 0x40000000, v9
v_fmamk_f32 v67, v8, 0x40400000, v9
v_fmamk_f32 v68, v8, 0x40800000, v9
v_fmamk_f32 v69, v8, 0x40a00000, v9
v_fmamk_f32 v70, v8, 0x40c00000, v9
v_fmamk_f32 v71, v8, 0x40e00000, v9
v_add_f32 v72, 0x3e800000, v64
v_add_f32 v73, 0x3e800000, v65
v_add_f32 v74, 0x3e800000, v66
v_add_f32 v75, 0x3e800000, v67
v_add_f32 v76, 0x3e800000, v68
v_add_f32 v77, 0x3e800000, v69
v_add_f32 v78, 0x3e800000, v70
v_add_f32 v79, 0x3e800000, v71
v_cos_f32 v64, v64
v_cos_f32 v65, v65
v_cos_f32 v66, v66
v_cos_f32 v67, v67
v_cos_f32 v68, v68
v_cos_f32 v69, v69
v_cos_f32 v70, v70
v_cos_f32 v71, v71
v_cos_f32 v72, v72
v_cos_f32 v73, v73
v_cos_f32 v74, v74
v_cos_f32 v75, v75
v_cos_f32 v76, v76
v_cos_f32 v77, v77
v_cos_f32 v78, v78
v_cos_f32 v79, v79
v_mul_f32 v64, s53, v64
v_mul_f32 v65, s52, v65
v_mul_f32 v66, s52, v66
v_mul_f32 v67, s52, v67
v_mul_f32 v68, s52, v68
v_mul_f32 v69, s52, v69
v_mul_f32 v70, s52, v70
v_mul_f32 v71, s52, v71
v_mul_f32 v72, s53, v72
v_mul_f32 v73, s52, v73
v_mul_f32 v74, s52, v74
v_mul_f32 v75, s52, v75
v_mul_f32 v76, s52, v76
v_mul_f32 v77, s52, v77
v_mul_f32 v78, s52, v78
v_mul_f32 v79, s52, v79
v_cvt_pk_bf16_f32 v64, v64, v65
v_cvt_pk_bf16_f32 v65, v66, v67
v_cvt_pk_bf16_f32 v66, v68, v69
v_cvt_pk_bf16_f32 v67, v70, v71
v_cvt_pk_bf16_f32 v68, v72, v73
v_cvt_pk_bf16_f32 v69, v74, v75
v_cvt_pk_bf16_f32 v70, v76, v77
v_cvt_pk_bf16_f32 v71, v78, v79
v_and_b32 v14, 15, v1
v_lshlrev_b32 v14, 4, v14
v_lshrrev_b32 v15, 4, v1
v_lshl_add_u32 v14, v15, 10, v14
s_lshl_b32 s46, s46, 12
s_lshl_b32 s49, s49, 6
s_add_u32 s46, s46, s49
s_lshl_b32 s47, s20, 16
s_add_u32 s46, s46, s47
s_add_u32 s46, s46, 7340032
buffer_store_dwordx4 v[64:67], v14, s[4:7], s46 offen sc1
buffer_store_dwordx4 v[68:71], v14, s[4:7], s46 offen offset:256 sc1
v_and_b32 v3, 31, v1
v_lshrrev_b32 v4, 5, v1
v_lshlrev_b32 v4, 2, v4
s_and_b32 s52, s20, 3
s_lshl_b32 s52, s52, 3
s_lshr_b32 s53, s20, 2
s_mul_i32 s53, s53, 1536
v_add_u32 v5, s52, v4
v_add_u32 v6, 0, v5
v_mad_u32_u24 v64, v6, v3, s53
v_add_u32 v6, 1, v5
v_mad_u32_u24 v65, v6, v3, s53
v_add_u32 v6, 2, v5
v_mad_u32_u24 v66, v6, v3, s53
v_add_u32 v6, 3, v5
v_mad_u32_u24 v67, v6, v3, s53
s_and_b32 s54, s20, 1
s_lshl_b32 s54, s54, 4
s_lshr_b32 s55, s20, 1
s_and_b32 s55, s55, 1
s_mul_i32 s55, s55, 48
s_lshr_b32 s56, s20, 2
v_lshl_add_u32 v7, v3, 1, s56
v_add_u32 v6, s54, v4
v_add_u32 v6, 0, v6
v_mad_u32_u24 v80, v6, v7, s55
v_add_u32 v6, s54, v4
v_add_u32 v6, 1, v6
v_mad_u32_u24 v81, v6, v7, s55
v_add_u32 v6, s54, v4
v_add_u32 v6, 2, v6
v_mad_u32_u24 v82, v6, v7, s55
v_add_u32 v6, s54, v4
v_add_u32 v6, 3, v6
v_mad_u32_u24 v83, v6, v7, s55
v_add_u32 v6, s54, v4
v_add_u32 v6, 8, v6
v_mad_u32_u24 v84, v6, v7, s55
v_add_u32 v6, s54, v4
v_add_u32 v6, 9, v6
v_mad_u32_u24 v85, v6, v7, s55
v_add_u32 v6, s54, v4
v_add_u32 v6, 10, v6
v_mad_u32_u24 v86, v6, v7, s55
v_add_u32 v6, s54, v4
v_add_u32 v6, 11, v6
v_mad_u32_u24 v87, v6, v7, s55
s_and_b32 s54, s20, 1
s_lshl_b32 s54, s54, 4
s_lshr_b32 s55, s20, 1
s_and_b32 s55, s55, 1
s_mul_i32 s55, s55, 48
v_add_u32 v6, s54, v4
v_add_u32 v6, 0, v6
v_lshl_add_u32 v6, v6, 1, 1
v_mad_u32_u24 v88, v6, v3, s55
v_add_u32 v6, s54, v4
v_add_u32 v6, 1, v6
v_lshl_add_u32 v6, v6, 1, 1
v_mad_u32_u24 v89, v6, v3, s55
v_add_u32 v6, s54, v4
v_add_u32 v6, 2, v6
v_lshl_add_u32 v6, v6, 1, 1
v_mad_u32_u24 v90, v6, v3, s55
v_add_u32 v6, s54, v4
v_add_u32 v6, 3, v6
v_lshl_add_u32 v6, v6, 1, 1
v_mad_u32_u24 v91, v6, v3, s55
v_add_u32 v6, s54, v4
v_add_u32 v6, 8, v6
v_lshl_add_u32 v6, v6, 1, 1
v_mad_u32_u24 v92, v6, v3, s55
v_add_u32 v6, s54, v4
v_add_u32 v6, 9, v6
v_lshl_add_u32 v6, v6, 1, 1
v_mad_u32_u24 v93, v6, v3, s55
v_add_u32 v6, s54, v4
v_add_u32 v6, 10, v6
v_lshl_add_u32 v6, v6, 1, 1
v_mad_u32_u24 v94, v6, v3, s55
v_add_u32 v6, s54, v4
v_add_u32 v6, 11, v6
v_lshl_add_u32 v6, v6, 1, 1
v_mad_u32_u24 v95, v6, v3, s55
v_and_b32 v64, 2047, v64
v_and_b32 v65, 2047, v65
v_and_b32 v66, 2047, v66
v_and_b32 v67, 2047, v67
v_cvt_f32_u32 v64, v64
v_cvt_f32_u32 v65, v65
v_cvt_f32_u32 v66, v66
v_cvt_f32_u32 v67, v67
v_mul_f32 v64, 0x3a000000, v64
v_mul_f32 v65, 0x3a000000, v65
v_mul_f32 v66, 0x3a000000, v66
v_mul_f32 v67, 0x3a000000, v67
v_cos_f32 v64, v64
v_cos_f32 v65, v65
v_cos_f32 v66, v66
v_cos_f32 v67, v67
v_and_b32 v80, 63, v80
v_and_b32 v81, 63, v81
v_and_b32 v82, 63, v82
v_and_b32 v83, 63, v83
v_and_b32 v84, 63, v84
v_and_b32 v85, 63, v85
v_and_b32 v86, 63, v86
v_and_b32 v87, 63, v87
v_and_b32 v88, 63, v88
v_and_b32 v89, 63, v89
v_and_b32 v90, 63, v90
v_and_b32 v91, 63, v91
v_and_b32 v92, 63, v92
v_and_b32 v93, 63, v93
v_and_b32 v94, 63, v94
v_and_b32 v95, 63, v95
v_cvt_f32_u32 v80, v80
v_cvt_f32_u32 v81, v81
v_cvt_f32_u32 v82, v82
v_cvt_f32_u32 v83, v83
v_cvt_f32_u32 v84, v84
v_cvt_f32_u32 v85, v85
v_cvt_f32_u32 v86, v86
v_cvt_f32_u32 v87, v87
v_cvt_f32_u32 v88, v88
v_cvt_f32_u32 v89, v89
v_cvt_f32_u32 v90, v90
v_cvt_f32_u32 v91, v91
v_cvt_f32_u32 v92, v92
v_cvt_f32_u32 v93, v93
v_cvt_f32_u32 v94, v94
v_cvt_f32_u32 v95, v95
v_mul_f32 v80, 0x3c800000, v80
v_mul_f32 v81, 0x3c800000, v81
v_mul_f32 v82, 0x3c800000, v82
v_mul_f32 v83, 0x3c800000, v83
v_mul_f32 v84, 0x3c800000, v84
v_mul_f32 v85, 0x3c800000, v85
v_mul_f32 v86, 0x3c800000, v86
v_mul_f32 v87, 0x3c800000, v87
v_mul_f32 v88, 0x3c800000, v88
v_mul_f32 v89, 0x3c800000, v89
v_mul_f32 v90, 0x3c800000, v90
v_mul_f32 v91, 0x3c800000, v91
v_mul_f32 v92, 0x3c800000, v92
v_mul_f32 v93, 0x3c800000, v93
v_mul_f32 v94, 0x3c800000, v94
v_mul_f32 v95, 0x3c800000, v95
v_cos_f32 v80, v80
v_cos_f32 v81, v81
v_cos_f32 v82, v82
v_cos_f32 v83, v83
v_cos_f32 v84, v84
v_cos_f32 v85, v85
v_cos_f32 v86, v86
v_cos_f32 v87, v87
v_cos_f32 v88, v88
v_cos_f32 v89, v89
v_cos_f32 v90, v90
v_cos_f32 v91, v91
v_cos_f32 v92, v92
v_cos_f32 v93, v93
v_cos_f32 v94, v94
v_cos_f32 v95, v95
s_lshl_b32 s52, s52, 8
s_lshr_b32 s53, s20, 2
s_lshl_b32 s53, s53, 10
s_add_u32 s52, s52, s53
s_add_u32 s52, s52, 131072
v_add_u32 v5, s52, v2
ds_write_b128 v5, v[64:67]
v_cvt_pk_bf16_f32 v80, v80, v81
v_cvt_pk_bf16_f32 v81, v82, v83
v_cvt_pk_bf16_f32 v82, v84, v85
v_cvt_pk_bf16_f32 v83, v86, v87
v_cvt_pk_bf16_f32 v84, v88, v89
v_cvt_pk_bf16_f32 v85, v90, v91
v_cvt_pk_bf16_f32 v86, v92, v93
v_cvt_pk_bf16_f32 v87, v94, v95
s_lshl_b32 s52, s20, 10
s_add_u32 s52, s52, 139264
v_add_u32 v5, s52, v2
ds_write_b128 v5, v[80:83]
s_cmp_ge_u32 s20, 4
s_cbranch_scc1 L_cf_skip_27
ds_write_b128 v5, v[84:87] offset:8192
L_cf_skip_27:
v_add_u32 v56, 131072, v2
v_add_u32 v57, 139264, v2
s_lshl_b32 s52, s20, 1
v_and_b32 v6, 15, v1
v_xor_b32 v6, s52, v6
v_lshlrev_b32 v6, 4, v6
v_lshl_add_u32 v6, v3, 10, v6
v_lshl_add_u32 v58, v4, 6, v6
v_xor_b32 v59, 16, v58
v_lshrrev_b32 v5, 2, v3
v_xor_b32 v6, s20, v5
v_lshlrev_b32 v6, 4, v6
v_lshl_add_u32 v6, v5, 7, v6
v_and_b32 v5, 3, v3
v_lshl_add_u32 v6, v5, 2, v6
v_lshl_add_u32 v6, v4, 11, v6
v_add_u32 v7, 65536, v6
s_waitcnt vmcnt(2) lgkmcnt(0)
s_barrier
s_cmp_lg_u32 s20, 0
s_cbranch_scc1 L_fl_28
v_mov_b32 v8, s22
v_lshlrev_b32 v9, 2, v1
s_mov_b32 exec_hi, 0
buffer_store_dword v8, v9, s[4:7], s57 offen sc1
s_mov_b64 exec, -1
L_fl_28:
v_lshlrev_b32 v6, 7, v3
s_lshl_b32 s57, s20, 12
s_add_u32 s57, s57, 262144
s_mov_b32 s69, 0
L_poll_29:
buffer_load_dword v64, v6, s[4:7], s57 offen sc1
s_waitcnt vmcnt(0)
v_xor_b32 v64, s22, v64
v_cmp_ne_u32 vcc, 0, v64
    s_nop 0
s_cmp_eq_u64 vcc, 0
s_cbranch_scc1 L_pollx_30
s_add_u32 s69, s69, 1
s_cmp_lt_u32 s69, 0x200000
s_cbranch_scc1 L_poll_29
L_pollx_30:
s_lshl_b32 s48, s44, 16
s_lshl_b32 s49, s20, 13
s_add_u32 s50, s48, s49
s_add_u32 s51, s50, 3145728
s_add_u32 m0, s49, 0
    s_nop 0
buffer_load_dwordx4 v2, s[4:7], s51 offen sc1  lds
s_add_u32 s51, s51, 1024
s_add_u32 m0, s49, 1024
    s_nop 0
buffer_load_dwordx4 v2, s[4:7], s51 offen sc1  lds
s_add_u32 s51, s51, 1024
s_add_u32 m0, s49, 2048
    s_nop 0
buffer_load_dwordx4 v2, s[4:7], s51 offen sc1  lds
s_add_u32 s51, s51, 1024
s_add_u32 m0, s49, 3072
    s_nop 0
buffer_load_dwordx4 v2, s[4:7], s51 offen sc1  lds
s_add_u32 s51, s51, 1024
s_add_u32 m0, s49, 4096
    s_nop 0
buffer_load_dwordx4 v2, s[4:7], s51 offen sc1  lds
s_add_u32 s51, s51, 1024
s_add_u32 m0, s49, 5120
    s_nop 0
buffer_load_dwordx4 v2, s[4:7], s51 offen sc1  lds
s_add_u32 s51, s51, 1024
s_add_u32 m0, s49, 6144
    s_nop 0
buffer_load_dwordx4 v2, s[4:7], s51 offen sc1  lds
s_add_u32 s51, s51, 1024
s_add_u32 m0, s49, 7168
    s_nop 0
buffer_load_dwordx4 v2, s[4:7], s51 offen sc1  lds
ds_read_b128 v[8:11], v57 offset:0
ds_read_b128 v[16:19], v57 offset:2048
ds_read_b128 v[12:15], v57 offset:1024
ds_read_b128 v[20:23], v57 offset:3072
ds_read_b128 v[32:35], v57 offset:8192
ds_read_b128 v[40:43], v57 offset:10240
ds_read_b128 v[36:39], v57 offset:9216
ds_read_b128 v[44:47], v57 offset:11264
ds_read_b128 v[224:227], v56 offset:0
ds_read_b128 v[240:243], v56 offset:1024
ds_read_b128 v[228:231], v56 offset:2048
ds_read_b128 v[244:247], v56 offset:3072
ds_read_b128 v[232:235], v56 offset:4096
ds_read_b128 v[248:251], v56 offset:5120
ds_read_b128 v[236:239], v56 offset:6144
ds_read_b128 v[252:255], v56 offset:7168
s_waitcnt lgkmcnt(8)
v_xor_b32 v24, 0x80008000, v16
v_xor_b32 v25, 0x80008000, v17
v_xor_b32 v26, 0x80008000, v18
v_xor_b32 v27, 0x80008000, v19
v_xor_b32 v28, 0x80008000, v20
v_xor_b32 v29, 0x80008000, v21
v_xor_b32 v30, 0x80008000, v22
v_xor_b32 v31, 0x80008000, v23
v_xor_b32 v48, 0x80008000, v40
v_xor_b32 v49, 0x80008000, v41
v_xor_b32 v50, 0x80008000, v42
v_xor_b32 v51, 0x80008000, v43
v_xor_b32 v52, 0x80008000, v44
v_xor_b32 v53, 0x80008000, v45
v_xor_b32 v54, 0x80008000, v46
v_xor_b32 v55, 0x80008000, v47
s_lshl_b32 s52, s20, 16
s_lshl_b32 s53, s44, 9
s_add_u32 s52, s52, s53
s_add_u32 s47, s52, 8388608
s_lshl_b32 s57, s44, 7
s_add_u32 s57, s57, 102400
s_waitcnt vmcnt(0)
s_barrier
ds_read_b128 v[192:195], v58 offset:0
ds_read_b128 v[196:199], v58 offset:512
ds_read_b128 v[200:203], v59 offset:0
ds_read_b128 v[204:207], v59 offset:512
ds_read_b128 v[208:211], v58 offset:32768
ds_read_b128 v[212:215], v58 offset:33280
ds_read_b128 v[216:219], v59 offset:32768
ds_read_b128 v[220:223], v59 offset:33280
s_waitcnt lgkmcnt(4)
v_mfma_f32_32x32x16_bf16 v[64:79], v[192:195], v[8:11], 0
s_add_u32 s51, s50, 5242880
s_add_u32 m0, s49, 65536
    s_nop 0
buffer_load_dwordx4 v2, s[4:7], s51 offen sc1  lds
v_mfma_f32_32x32x16_bf16 v[64:79], v[196:199], v[12:15], v[64:79]
v_mfma_f32_32x32x16_bf16 v[64:79], v[200:203], v[16:19], v[64:79]
s_add_u32 s51, s51, 1024
s_add_u32 m0, s49, 66560
    s_nop 0
buffer_load_dwordx4 v2, s[4:7], s51 offen sc1  lds
v_mfma_f32_32x32x16_bf16 v[64:79], v[204:207], v[20:23], v[64:79]
v_mfma_f32_32x32x16_bf16 v[96:111], v[200:203], v[8:11], 0
s_add_u32 s51, s51, 1024
s_add_u32 m0, s49, 67584
    s_nop 0
buffer_load_dwordx4 v2, s[4:7], s51 offen sc1  lds
v_mfma_f32_32x32x16_bf16 v[96:111], v[204:207], v[12:15], v[96:111]
v_mfma_f32_32x32x16_bf16 v[96:111], v[192:195], v[24:27], v[96:111]
s_add_u32 s51, s51, 1024
s_add_u32 m0, s49, 68608
    s_nop 0
buffer_load_dwordx4 v2, s[4:7], s51 offen sc1  lds
v_mfma_f32_32x32x16_bf16 v[96:111], v[196:199], v[28:31], v[96:111]
s_waitcnt lgkmcnt(0)
v_mfma_f32_32x32x16_bf16 v[80:95], v[208:211], v[32:35], 0
s_add_u32 s51, s51, 1024
s_add_u32 m0, s49, 69632
    s_nop 0
buffer_load_dwordx4 v2, s[4:7], s51 offen sc1  lds
v_mfma_f32_32x32x16_bf16 v[80:95], v[212:215], v[36:39], v[80:95]
v_mfma_f32_32x32x16_bf16 v[80:95], v[216:219], v[40:43], v[80:95]
s_add_u32 s51, s51, 1024
s_add_u32 m0, s49, 70656
    s_nop 0
buffer_load_dwordx4 v2, s[4:7], s51 offen sc1  lds
v_mfma_f32_32x32x16_bf16 v[80:95], v[220:223], v[44:47], v[80:95]
v_mfma_f32_32x32x16_bf16 v[112:127], v[216:219], v[32:35], 0
s_add_u32 s51, s51, 1024
s_add_u32 m0, s49, 71680
    s_nop 0
buffer_load_dwordx4 v2, s[4:7], s51 offen sc1  lds
v_mfma_f32_32x32x16_bf16 v[112:127], v[220:223], v[36:39], v[112:127]
v_mfma_f32_32x32x16_bf16 v[112:127], v[208:211], v[48:51], v[112:127]
s_add_u32 s51, s51, 1024
s_add_u32 m0, s49, 72704
    s_nop 0
buffer_load_dwordx4 v2, s[4:7], s51 offen sc1  lds
v_mfma_f32_32x32x16_bf16 v[112:127], v[212:215], v[52:55], v[112:127]
ds_read_b128 v[32:35], v57 offset:4096
ds_read_b128 v[40:43], v57 offset:6144
ds_read_b128 v[36:39], v57 offset:5120
ds_read_b128 v[44:47], v57 offset:7168
v_pk_add_f32 v[128:129], v[64:65], v[80:81]
v_pk_add_f32 v[144:145], v[64:65], v[80:81] neg_lo:[0,1] neg_hi:[0,1]
    s_nop 5
v_pk_add_f32 v[160:161], v[96:97], v[112:113]
v_pk_add_f32 v[176:177], v[96:97], v[112:113] neg_lo:[0,1] neg_hi:[0,1]
v_pk_mul_f32 v[60:61], v[128:129], v[240:241]
v_pk_mul_f32 v[62:63], v[144:145], v[240:241]
v_pk_mul_f32 v[128:129], v[128:129], v[224:225]
v_pk_mul_f32 v[144:145], v[144:145], v[224:225]
v_pk_fma_f32 v[128:129], v[160:161], v[240:241], v[128:129]
v_pk_fma_f32 v[144:145], v[176:177], v[240:241], v[144:145]
v_pk_fma_f32 v[160:161], v[160:161], v[224:225], v[60:61] neg_lo:[0,0,1] neg_hi:[0,0,1]
v_pk_fma_f32 v[176:177], v[176:177], v[224:225], v[62:63] neg_lo:[0,0,1] neg_hi:[0,0,1]
v_pk_add_f32 v[130:131], v[66:67], v[82:83]
v_pk_add_f32 v[146:147], v[66:67], v[82:83] neg_lo:[0,1] neg_hi:[0,1]
v_pk_add_f32 v[162:163], v[98:99], v[114:115]
v_pk_add_f32 v[178:179], v[98:99], v[114:115] neg_lo:[0,1] neg_hi:[0,1]
v_pk_mul_f32 v[60:61], v[130:131], v[242:243]
v_pk_mul_f32 v[62:63], v[146:147], v[242:243]
v_pk_mul_f32 v[130:131], v[130:131], v[226:227]
v_pk_mul_f32 v[146:147], v[146:147], v[226:227]
v_pk_fma_f32 v[130:131], v[162:163], v[242:243], v[130:131]
v_pk_fma_f32 v[146:147], v[178:179], v[242:243], v[146:147]
v_pk_fma_f32 v[162:163], v[162:163], v[226:227], v[60:61] neg_lo:[0,0,1] neg_hi:[0,0,1]
v_pk_fma_f32 v[178:179], v[178:179], v[226:227], v[62:63] neg_lo:[0,0,1] neg_hi:[0,0,1]
v_pk_add_f32 v[132:133], v[68:69], v[84:85]
v_pk_add_f32 v[148:149], v[68:69], v[84:85] neg_lo:[0,1] neg_hi:[0,1]
v_pk_add_f32 v[164:165], v[100:101], v[116:117]
v_pk_add_f32 v[180:181], v[100:101], v[116:117] neg_lo:[0,1] neg_hi:[0,1]
v_pk_mul_f32 v[60:61], v[132:133], v[244:245]
v_pk_mul_f32 v[62:63], v[148:149], v[244:245]
v_pk_mul_f32 v[132:133], v[132:133], v[228:229]
v_pk_mul_f32 v[148:149], v[148:149], v[228:229]
v_pk_fma_f32 v[132:133], v[164:165], v[244:245], v[132:133]
v_pk_fma_f32 v[148:149], v[180:181], v[244:245], v[148:149]
v_pk_fma_f32 v[164:165], v[164:165], v[228:229], v[60:61] neg_lo:[0,0,1] neg_hi:[0,0,1]
v_pk_fma_f32 v[180:181], v[180:181], v[228:229], v[62:63] neg_lo:[0,0,1] neg_hi:[0,0,1]
v_pk_add_f32 v[134:135], v[70:71], v[86:87]
v_pk_add_f32 v[150:151], v[70:71], v[86:87] neg_lo:[0,1] neg_hi:[0,1]
v_pk_add_f32 v[166:167], v[102:103], v[118:119]
v_pk_add_f32 v[182:183], v[102:103], v[118:119] neg_lo:[0,1] neg_hi:[0,1]
v_pk_mul_f32 v[60:61], v[134:135], v[246:247]
v_pk_mul_f32 v[62:63], v[150:151], v[246:247]
v_pk_mul_f32 v[134:135], v[134:135], v[230:231]
v_pk_mul_f32 v[150:151], v[150:151], v[230:231]
v_pk_fma_f32 v[134:135], v[166:167], v[246:247], v[134:135]
v_pk_fma_f32 v[150:151], v[182:183], v[246:247], v[150:151]
v_pk_fma_f32 v[166:167], v[166:167], v[230:231], v[60:61] neg_lo:[0,0,1] neg_hi:[0,0,1]
v_pk_fma_f32 v[182:183], v[182:183], v[230:231], v[62:63] neg_lo:[0,0,1] neg_hi:[0,0,1]
v_pk_add_f32 v[136:137], v[72:73], v[88:89]
v_pk_add_f32 v[152:153], v[72:73], v[88:89] neg_lo:[0,1] neg_hi:[0,1]
v_pk_add_f32 v[168:169], v[104:105], v[120:121]
v_pk_add_f32 v[184:185], v[104:105], v[120:121] neg_lo:[0,1] neg_hi:[0,1]
v_pk_mul_f32 v[60:61], v[136:137], v[248:249]
v_pk_mul_f32 v[62:63], v[152:153], v[248:249]
v_pk_mul_f32 v[136:137], v[136:137], v[232:233]
v_pk_mul_f32 v[152:153], v[152:153], v[232:233]
v_pk_fma_f32 v[136:137], v[168:169], v[248:249], v[136:137]
v_pk_fma_f32 v[152:153], v[184:185], v[248:249], v[152:153]
v_pk_fma_f32 v[168:169], v[168:169], v[232:233], v[60:61] neg_lo:[0,0,1] neg_hi:[0,0,1]
v_pk_fma_f32 v[184:185], v[184:185], v[232:233], v[62:63] neg_lo:[0,0,1] neg_hi:[0,0,1]
v_pk_add_f32 v[138:139], v[74:75], v[90:91]
v_pk_add_f32 v[154:155], v[74:75], v[90:91] neg_lo:[0,1] neg_hi:[0,1]
v_pk_add_f32 v[170:171], v[106:107], v[122:123]
v_pk_add_f32 v[186:187], v[106:107], v[122:123] neg_lo:[0,1] neg_hi:[0,1]
v_pk_mul_f32 v[60:61], v[138:139], v[250:251]
v_pk_mul_f32 v[62:63], v[154:155], v[250:251]
v_pk_mul_f32 v[138:139], v[138:139], v[234:235]
v_pk_mul_f32 v[154:155], v[154:155], v[234:235]
v_pk_fma_f32 v[138:139], v[170:171], v[250:251], v[138:139]
v_pk_fma_f32 v[154:155], v[186:187], v[250:251], v[154:155]
v_pk_fma_f32 v[170:171], v[170:171], v[234:235], v[60:61] neg_lo:[0,0,1] neg_hi:[0,0,1]
v_pk_fma_f32 v[186:187], v[186:187], v[234:235], v[62:63] neg_lo:[0,0,1] neg_hi:[0,0,1]
v_pk_add_f32 v[140:141], v[76:77], v[92:93]
v_pk_add_f32 v[156:157], v[76:77], v[92:93] neg_lo:[0,1] neg_hi:[0,1]
v_pk_add_f32 v[172:173], v[108:109], v[124:125]
v_pk_add_f32 v[188:189], v[108:109], v[124:125] neg_lo:[0,1] neg_hi:[0,1]
v_pk_mul_f32 v[60:61], v[140:141], v[252:253]
v_pk_mul_f32 v[62:63], v[156:157], v[252:253]
v_pk_mul_f32 v[140:141], v[140:141], v[236:237]
v_pk_mul_f32 v[156:157], v[156:157], v[236:237]
v_pk_fma_f32 v[140:141], v[172:173], v[252:253], v[140:141]
v_pk_fma_f32 v[156:157], v[188:189], v[252:253], v[156:157]
v_pk_fma_f32 v[172:173], v[172:173], v[236:237], v[60:61] neg_lo:[0,0,1] neg_hi:[0,0,1]
v_pk_fma_f32 v[188:189], v[188:189], v[236:237], v[62:63] neg_lo:[0,0,1] neg_hi:[0,0,1]
v_pk_add_f32 v[142:143], v[78:79], v[94:95]
v_pk_add_f32 v[158:159], v[78:79], v[94:95] neg_lo:[0,1] neg_hi:[0,1]
v_pk_add_f32 v[174:175], v[110:111], v[126:127]
v_pk_add_f32 v[190:191], v[110:111], v[126:127] neg_lo:[0,1] neg_hi:[0,1]
v_pk_mul_f32 v[60:61], v[142:143], v[254:255]
v_pk_mul_f32 v[62:63], v[158:159], v[254:255]
v_pk_mul_f32 v[142:143], v[142:143], v[238:239]
v_pk_mul_f32 v[158:159], v[158:159], v[238:239]
v_pk_fma_f32 v[142:143], v[174:175], v[254:255], v[142:143]
v_pk_fma_f32 v[158:159], v[190:191], v[254:255], v[158:159]
v_pk_fma_f32 v[174:175], v[174:175], v[238:239], v[60:61] neg_lo:[0,0,1] neg_hi:[0,0,1]
v_pk_fma_f32 v[190:191], v[190:191], v[238:239], v[62:63] neg_lo:[0,0,1] neg_hi:[0,0,1]
v_cvt_pk_bf16_f32 v192, v128, v129
v_cvt_pk_bf16_f32 v193, v130, v131
v_cvt_pk_bf16_f32 v194, v132, v133
v_cvt_pk_bf16_f32 v195, v134, v135
v_cvt_pk_bf16_f32 v196, v136, v137
v_cvt_pk_bf16_f32 v197, v138, v139
v_cvt_pk_bf16_f32 v198, v140, v141
v_cvt_pk_bf16_f32 v199, v142, v143
v_cvt_pk_bf16_f32 v200, v160, v161
v_cvt_pk_bf16_f32 v201, v162, v163
v_cvt_pk_bf16_f32 v202, v164, v165
v_cvt_pk_bf16_f32 v203, v166, v167
v_cvt_pk_bf16_f32 v204, v168, v169
v_cvt_pk_bf16_f32 v205, v170, v171
v_cvt_pk_bf16_f32 v206, v172, v173
v_cvt_pk_bf16_f32 v207, v174, v175
s_waitcnt lgkmcnt(0)
v_mfma_f32_32x32x16_bf16 v[64:79], v[8:11], v[192:195], 0
v_cvt_pk_bf16_f32 v208, v144, v145
v_cvt_pk_bf16_f32 v209, v146, v147
v_cvt_pk_bf16_f32 v210, v148, v149
v_mfma_f32_32x32x16_bf16 v[64:79], v[12:15], v[196:199], v[64:79]
v_cvt_pk_bf16_f32 v211, v150, v151
v_cvt_pk_bf16_f32 v212, v152, v153
v_cvt_pk_bf16_f32 v213, v154, v155
v_mfma_f32_32x32x16_bf16 v[64:79], v[16:19], v[200:203], v[64:79]
v_cvt_pk_bf16_f32 v214, v156, v157
v_cvt_pk_bf16_f32 v215, v158, v159
v_cvt_pk_bf16_f32 v216, v176, v177
v_mfma_f32_32x32x16_bf16 v[64:79], v[20:23], v[204:207], v[64:79]
v_cvt_pk_bf16_f32 v217, v178, v179
v_cvt_pk_bf16_f32 v218, v180, v181
v_cvt_pk_bf16_f32 v219, v182, v183
v_mfma_f32_32x32x16_bf16 v[96:111], v[8:11], v[200:203], 0
v_cvt_pk_bf16_f32 v220, v184, v185
v_cvt_pk_bf16_f32 v221, v186, v187
v_cvt_pk_bf16_f32 v222, v188, v189
v_mfma_f32_32x32x16_bf16 v[96:111], v[12:15], v[204:207], v[96:111]
v_cvt_pk_bf16_f32 v223, v190, v191
v_xor_b32 v48, 0x80008000, v40
v_xor_b32 v49, 0x80008000, v41
v_mfma_f32_32x32x16_bf16 v[96:111], v[24:27], v[192:195], v[96:111]
v_xor_b32 v50, 0x80008000, v42
v_xor_b32 v51, 0x80008000, v43
v_xor_b32 v52, 0x80008000, v44
v_mfma_f32_32x32x16_bf16 v[96:111], v[28:31], v[196:199], v[96:111]
v_xor_b32 v53, 0x80008000, v45
v_xor_b32 v54, 0x80008000, v46
v_xor_b32 v55, 0x80008000, v47
s_waitcnt vmcnt(0)
s_barrier
ds_read2st64_b32 v[224:225], v7 offset0:0 offset1:8
ds_read2st64_b32 v[226:227], v7 offset0:16 offset1:24
ds_read2st64_b32 v[228:229], v7 offset0:64 offset1:72
ds_read2st64_b32 v[230:231], v7 offset0:80 offset1:88
ds_read2st64_b32 v[232:233], v7 offset0:128 offset1:136
ds_read2st64_b32 v[234:235], v7 offset0:144 offset1:152
ds_read2st64_b32 v[236:237], v7 offset0:192 offset1:200
ds_read2st64_b32 v[238:239], v7 offset0:208 offset1:216
v_mfma_f32_32x32x16_bf16 v[80:95], v[32:35], v[208:211], 0
ds_read2st64_b32 v[240:241], v7 offset0:4 offset1:12
ds_read2st64_b32 v[242:243], v7 offset0:20 offset1:28
ds_read2st64_b32 v[244:245], v7 offset0:68 offset1:76
ds_read2st64_b32 v[246:247], v7 offset0:84 offset1:92
v_mfma_f32_32x32x16_bf16 v[80:95], v[36:39], v[212:215], v[80:95]
ds_read2st64_b32 v[248:249], v7 offset0:132 offset1:140
ds_read2st64_b32 v[250:251], v7 offset0:148 offset1:156
ds_read2st64_b32 v[252:253], v7 offset0:196 offset1:204
ds_read2st64_b32 v[254:255], v7 offset0:212 offset1:220
s_waitcnt lgkmcnt(8)
v_mfma_f32_32x32x16_bf16 v[80:95], v[40:43], v[216:219], v[80:95]
v_lshlrev_b32 v60, 16, v224
v_lshlrev_b32 v61, 16, v225
v_and_b32 v224, 0xffff0000, v224
v_and_b32 v225, 0xffff0000, v225
v_mul_f32 v128, v64, v60
v_mul_f32 v160, v96, v60
v_mul_f32 v129, v65, v61
v_mul_f32 v161, v97, v61
v_fma_f32 v128, -v96, v224, v128
v_fmac_f32 v160, v64, v224
v_fma_f32 v129, -v97, v225, v129
v_fmac_f32 v161, v65, v225
v_lshlrev_b32 v62, 16, v226
v_lshlrev_b32 v63, 16, v227
v_and_b32 v226, 0xffff0000, v226
v_and_b32 v227, 0xffff0000, v227
v_mfma_f32_32x32x16_bf16 v[80:95], v[44:47], v[220:223], v[80:95]
v_mul_f32 v130, v66, v62
v_mul_f32 v162, v98, v62
v_mul_f32 v131, v67, v63
v_mul_f32 v163, v99, v63
v_fma_f32 v130, -v98, v226, v130
v_fmac_f32 v162, v66, v226
v_fma_f32 v131, -v99, v227, v131
v_fmac_f32 v163, v67, v227
v_lshlrev_b32 v60, 16, v228
v_lshlrev_b32 v61, 16, v229
v_and_b32 v228, 0xffff0000, v228
v_and_b32 v229, 0xffff0000, v229
v_mul_f32 v132, v68, v60
v_mul_f32 v164, v100, v60
v_mul_f32 v133, v69, v61
v_mul_f32 v165, v101, v61
v_mfma_f32_32x32x16_bf16 v[112:127], v[32:35], v[216:219], 0
v_fma_f32 v132, -v100, v228, v132
v_fmac_f32 v164, v68, v228
v_fma_f32 v133, -v101, v229, v133
v_fmac_f32 v165, v69, v229
v_lshlrev_b32 v62, 16, v230
v_lshlrev_b32 v63, 16, v231
v_and_b32 v230, 0xffff0000, v230
v_and_b32 v231, 0xffff0000, v231
v_mul_f32 v134, v70, v62
v_mul_f32 v166, v102, v62
v_mul_f32 v135, v71, v63
v_mul_f32 v167, v103, v63
v_fma_f32 v134, -v102, v230, v134
v_fmac_f32 v166, v70, v230
v_fma_f32 v135, -v103, v231, v135
v_fmac_f32 v167, v71, v231
v_mfma_f32_32x32x16_bf16 v[112:127], v[36:39], v[220:223], v[112:127]
v_lshlrev_b32 v60, 16, v232
v_lshlrev_b32 v61, 16, v233
v_and_b32 v232, 0xffff0000, v232
v_and_b32 v233, 0xffff0000, v233
v_mul_f32 v136, v72, v60
v_mul_f32 v168, v104, v60
v_mul_f32 v137, v73, v61
v_mul_f32 v169, v105, v61
v_fma_f32 v136, -v104, v232, v136
v_fmac_f32 v168, v72, v232
v_fma_f32 v137, -v105, v233, v137
v_fmac_f32 v169, v73, v233
v_lshlrev_b32 v62, 16, v234
v_lshlrev_b32 v63, 16, v235
v_and_b32 v234, 0xffff0000, v234
v_and_b32 v235, 0xffff0000, v235
v_mfma_f32_32x32x16_bf16 v[112:127], v[48:51], v[208:211], v[112:127]
v_mul_f32 v138, v74, v62
v_mul_f32 v170, v106, v62
v_mul_f32 v139, v75, v63
v_mul_f32 v171, v107, v63
v_fma_f32 v138, -v106, v234, v138
v_fmac_f32 v170, v74, v234
v_fma_f32 v139, -v107, v235, v139
v_fmac_f32 v171, v75, v235
v_lshlrev_b32 v60, 16, v236
v_lshlrev_b32 v61, 16, v237
v_and_b32 v236, 0xffff0000, v236
v_and_b32 v237, 0xffff0000, v237
v_mul_f32 v140, v76, v60
v_mul_f32 v172, v108, v60
v_mul_f32 v141, v77, v61
v_mul_f32 v173, v109, v61
v_mfma_f32_32x32x16_bf16 v[112:127], v[52:55], v[212:215], v[112:127]
v_fma_f32 v140, -v108, v236, v140
v_fmac_f32 v172, v76, v236
v_fma_f32 v141, -v109, v237, v141
v_fmac_f32 v173, v77, v237
v_lshlrev_b32 v62, 16, v238
v_lshlrev_b32 v63, 16, v239
v_and_b32 v238, 0xffff0000, v238
v_and_b32 v239, 0xffff0000, v239
v_mul_f32 v142, v78, v62
v_mul_f32 v174, v110, v62
v_mul_f32 v143, v79, v63
v_mul_f32 v175, v111, v63
v_fma_f32 v142, -v110, v238, v142
v_fmac_f32 v174, v78, v238
v_fma_f32 v143, -v111, v239, v143
v_fmac_f32 v175, v79, v239
ds_read_b128 v[32:35], v57 offset:8192
ds_read_b128 v[40:43], v57 offset:10240
ds_read_b128 v[36:39], v57 offset:9216
ds_read_b128 v[44:47], v57 offset:11264
v_cvt_pk_bf16_f32 v192, v128, v129
v_cvt_pk_bf16_f32 v193, v130, v131
v_cvt_pk_bf16_f32 v194, v132, v133
v_cvt_pk_bf16_f32 v195, v134, v135
v_cvt_pk_bf16_f32 v196, v136, v137
v_cvt_pk_bf16_f32 v197, v138, v139
v_cvt_pk_bf16_f32 v198, v140, v141
v_cvt_pk_bf16_f32 v199, v142, v143
v_cvt_pk_bf16_f32 v200, v160, v161
v_cvt_pk_bf16_f32 v201, v162, v163
v_cvt_pk_bf16_f32 v202, v164, v165
v_cvt_pk_bf16_f32 v203, v166, v167
v_cvt_pk_bf16_f32 v204, v168, v169
v_cvt_pk_bf16_f32 v205, v170, v171
v_cvt_pk_bf16_f32 v206, v172, v173
v_cvt_pk_bf16_f32 v207, v174, v175
s_lshr_b32 s44, s68, 1
s_lshl_b32 s44, s44, 3
s_and_b32 s45, s23, 7
s_add_u32 s44, s44, s45
s_and_b32 s45, s68, 1
s_lshl_b32 s45, s45, 2
s_lshr_b32 s46, s23, 3
s_add_u32 s45, s45, s46
s_and_b32 s48, s20, 3
s_lshr_b32 s49, s20, 2
s_lshl_b32 s50, s44, 2
s_add_u32 s50, s50, s48
s_mov_b32 s12, s36
s_and_b32 s13, s37, 0xffff
s_mov_b32 s14, 1835008
s_mov_b32 s15, 0x00020000
v_lshrrev_b32 v58, 3, v1
v_bfe_u32 v5, v1, 4, 2
v_lshlrev_b32 v5, 1, v5
v_and_b32 v6, 7, v1
v_xor_b32 v5, v5, v6
v_lshlrev_b32 v58, 10, v58
v_lshl_add_u32 v58, v5, 4, v58
s_lshl_b32 s46, s48, 15
s_lshl_b32 s51, s45, 7
s_add_u32 s51, s51, s46
s_mul_i32 s55, s49, 917504
s_add_u32 s51, s51, s55
s_lshl_b32 s46, s48, 12
s_lshl_b32 s55, s49, 14
s_add_u32 s55, s55, s46
v_lshrrev_b32 v5, 3, v1
v_and_b32 v59, 3, v5
v_lshrrev_b32 v5, 2, v5
v_lshl_or_b32 v59, v5, 3, v59
v_lshlrev_b32 v59, 10, v59
v_and_b32 v6, 7, v1
v_lshl_add_u32 v59, v6, 4, v59
s_and_b32 s56, s20, 6
s_lshl_b32 s56, s56, 3
s_and_b32 s46, s20, 1
s_lshl_b32 s46, s46, 2
s_add_u32 s56, s56, s46
s_lshl_b32 s46, s44, 6
s_add_u32 s56, s56, s46
s_lshl_b32 s56, s56, 10
s_lshl_b32 s46, s45, 7
s_add_u32 s56, s56, s46
s_waitcnt lgkmcnt(4)
v_mfma_f32_32x32x16_bf16 v[64:79], v[192:195], v[8:11], 0
v_mfma_f32_32x32x16_bf16 v[64:79], v[196:199], v[12:15], v[64:79]
v_lshlrev_b32 v60, 16, v240
v_lshlrev_b32 v61, 16, v241
v_and_b32 v240, 0xffff0000, v240
v_and_b32 v241, 0xffff0000, v241
v_mul_f32 v144, v80, v60
v_mul_f32 v176, v112, v60
v_mul_f32 v145, v81, v61
v_mul_f32 v177, v113, v61
v_fma_f32 v144, -v112, v240, v144
v_fmac_f32 v176, v80, v240
v_fma_f32 v145, -v113, v241, v145
v_fmac_f32 v177, v81, v241
v_lshlrev_b32 v62, 16, v242
v_lshlrev_b32 v63, 16, v243
v_and_b32 v242, 0xffff0000, v242
v_and_b32 v243, 0xffff0000, v243
v_mfma_f32_32x32x16_bf16 v[64:79], v[200:203], v[24:27], v[64:79]
v_mul_f32 v146, v82, v62
v_mul_f32 v178, v114, v62
v_mul_f32 v147, v83, v63
v_mul_f32 v179, v115, v63
v_fma_f32 v146, -v114, v242, v146
v_fmac_f32 v178, v82, v242
v_fma_f32 v147, -v115, v243, v147
v_fmac_f32 v179, v83, v243
v_lshlrev_b32 v60, 16, v244
v_lshlrev_b32 v61, 16, v245
v_and_b32 v244, 0xffff0000, v244
v_and_b32 v245, 0xffff0000, v245
v_mul_f32 v148, v84, v60
v_mul_f32 v180, v116, v60
v_mul_f32 v149, v85, v61
v_mul_f32 v181, v117, v61
v_mfma_f32_32x32x16_bf16 v[64:79], v[204:207], v[28:31], v[64:79]
v_fma_f32 v148, -v116, v244, v148
v_fmac_f32 v180, v84, v244
v_fma_f32 v149, -v117, v245, v149
v_fmac_f32 v181, v85, v245
v_lshlrev_b32 v62, 16, v246
v_lshlrev_b32 v63, 16, v247
v_and_b32 v246, 0xffff0000, v246
v_and_b32 v247, 0xffff0000, v247
v_mul_f32 v150, v86, v62
v_mul_f32 v182, v118, v62
v_mul_f32 v151, v87, v63
v_mul_f32 v183, v119, v63
v_fma_f32 v150, -v118, v246, v150
v_fmac_f32 v182, v86, v246
v_fma_f32 v151, -v119, v247, v151
v_fmac_f32 v183, v87, v247
v_mfma_f32_32x32x16_bf16 v[96:111], v[200:203], v[8:11], 0
v_lshlrev_b32 v60, 16, v248
v_lshlrev_b32 v61, 16, v249
v_and_b32 v248, 0xffff0000, v248
v_and_b32 v249, 0xffff0000, v249
v_mul_f32 v152, v88, v60
v_mul_f32 v184, v120, v60
v_mul_f32 v153, v89, v61
v_mul_f32 v185, v121, v61
v_fma_f32 v152, -v120, v248, v152
v_fmac_f32 v184, v88, v248
v_fma_f32 v153, -v121, v249, v153
v_fmac_f32 v185, v89, v249
v_lshlrev_b32 v62, 16, v250
v_lshlrev_b32 v63, 16, v251
v_and_b32 v250, 0xffff0000, v250
v_and_b32 v251, 0xffff0000, v251
v_mfma_f32_32x32x16_bf16 v[96:111], v[204:207], v[12:15], v[96:111]
v_mul_f32 v154, v90, v62
v_mul_f32 v186, v122, v62
v_mul_f32 v155, v91, v63
v_mul_f32 v187, v123, v63
v_fma_f32 v154, -v122, v250, v154
v_fmac_f32 v186, v90, v250
v_fma_f32 v155, -v123, v251, v155
v_fmac_f32 v187, v91, v251
v_lshlrev_b32 v60, 16, v252
v_lshlrev_b32 v61, 16, v253
v_and_b32 v252, 0xffff0000, v252
v_and_b32 v253, 0xffff0000, v253
v_mul_f32 v156, v92, v60
v_mul_f32 v188, v124, v60
v_mul_f32 v157, v93, v61
v_mul_f32 v189, v125, v61
v_mfma_f32_32x32x16_bf16 v[96:111], v[192:195], v[16:19], v[96:111]
v_fma_f32 v156, -v124, v252, v156
v_fmac_f32 v188, v92, v252
v_fma_f32 v157, -v125, v253, v157
v_fmac_f32 v189, v93, v253
v_lshlrev_b32 v62, 16, v254
v_lshlrev_b32 v63, 16, v255
v_and_b32 v254, 0xffff0000, v254
v_and_b32 v255, 0xffff0000, v255
v_mul_f32 v158, v94, v62
v_mul_f32 v190, v126, v62
v_mul_f32 v159, v95, v63
v_mul_f32 v191, v127, v63
v_fma_f32 v158, -v126, v254, v158
v_fmac_f32 v190, v94, v254
v_fma_f32 v159, -v127, v255, v159
v_fmac_f32 v191, v95, v255
v_mfma_f32_32x32x16_bf16 v[96:111], v[196:199], v[20:23], v[96:111]
v_cvt_pk_bf16_f32 v208, v144, v145
v_cvt_pk_bf16_f32 v209, v146, v147
v_cvt_pk_bf16_f32 v210, v148, v149
v_cvt_pk_bf16_f32 v211, v150, v151
v_cvt_pk_bf16_f32 v212, v152, v153
v_cvt_pk_bf16_f32 v213, v154, v155
v_cvt_pk_bf16_f32 v214, v156, v157
v_cvt_pk_bf16_f32 v215, v158, v159
v_cvt_pk_bf16_f32 v216, v176, v177
v_cvt_pk_bf16_f32 v217, v178, v179
v_cvt_pk_bf16_f32 v218, v180, v181
v_cvt_pk_bf16_f32 v219, v182, v183
v_cvt_pk_bf16_f32 v220, v184, v185
v_cvt_pk_bf16_f32 v221, v186, v187
v_cvt_pk_bf16_f32 v222, v188, v189
v_cvt_pk_bf16_f32 v223, v190, v191
s_waitcnt lgkmcnt(0)
v_xor_b32 v48, 0x80008000, v40
v_xor_b32 v49, 0x80008000, v41
v_xor_b32 v50, 0x80008000, v42
v_xor_b32 v51, 0x80008000, v43
v_xor_b32 v52, 0x80008000, v44
v_xor_b32 v53, 0x80008000, v45
v_xor_b32 v54, 0x80008000, v46
v_xor_b32 v55, 0x80008000, v47
ds_read_b128 v[224:227], v56 offset:0
ds_read_b128 v[240:243], v56 offset:1024
ds_read_b128 v[228:231], v56 offset:2048
ds_read_b128 v[244:247], v56 offset:3072
ds_read_b128 v[232:235], v56 offset:4096
ds_read_b128 v[248:251], v56 offset:5120
ds_read_b128 v[236:239], v56 offset:6144
ds_read_b128 v[252:255], v56 offset:7168
v_mfma_f32_32x32x16_bf16 v[80:95], v[208:211], v[32:35], 0
v_mfma_f32_32x32x16_bf16 v[80:95], v[212:215], v[36:39], v[80:95]
v_mfma_f32_32x32x16_bf16 v[80:95], v[216:219], v[48:51], v[80:95]
v_mfma_f32_32x32x16_bf16 v[80:95], v[220:223], v[52:55], v[80:95]
v_mfma_f32_32x32x16_bf16 v[112:127], v[216:219], v[32:35], 0
v_mfma_f32_32x32x16_bf16 v[112:127], v[220:223], v[36:39], v[112:127]
v_mfma_f32_32x32x16_bf16 v[112:127], v[208:211], v[40:43], v[112:127]
v_mfma_f32_32x32x16_bf16 v[112:127], v[212:215], v[44:47], v[112:127]
ds_read_b128 v[32:35], v57 offset:4096
ds_read_b128 v[40:43], v57 offset:6144
ds_read_b128 v[36:39], v57 offset:5120
ds_read_b128 v[44:47], v57 offset:7168
s_waitcnt lgkmcnt(4)
    s_nop 2
v_pk_add_f32 v[128:129], v[64:65], v[80:81]
v_pk_add_f32 v[144:145], v[64:65], v[80:81] neg_lo:[0,1] neg_hi:[0,1]
    s_nop 1
v_pk_add_f32 v[160:161], v[96:97], v[112:113]
v_pk_add_f32 v[176:177], v[96:97], v[112:113] neg_lo:[0,1] neg_hi:[0,1]
v_pk_mul_f32 v[60:61], v[128:129], v[240:241]
v_pk_mul_f32 v[62:63], v[144:145], v[240:241]
v_pk_mul_f32 v[128:129], v[128:129], v[224:225]
v_pk_mul_f32 v[144:145], v[144:145], v[224:225]
v_pk_fma_f32 v[128:129], v[160:161], v[240:241], v[128:129] neg_lo:[1,0,0] neg_hi:[1,0,0]
v_pk_fma_f32 v[144:145], v[176:177], v[240:241], v[144:145] neg_lo:[1,0,0] neg_hi:[1,0,0]
v_pk_fma_f32 v[160:161], v[160:161], v[224:225], v[60:61]
v_pk_fma_f32 v[176:177], v[176:177], v[224:225], v[62:63]
v_pk_add_f32 v[130:131], v[66:67], v[82:83]
v_pk_add_f32 v[146:147], v[66:67], v[82:83] neg_lo:[0,1] neg_hi:[0,1]
v_pk_add_f32 v[162:163], v[98:99], v[114:115]
v_pk_add_f32 v[178:179], v[98:99], v[114:115] neg_lo:[0,1] neg_hi:[0,1]
v_pk_mul_f32 v[60:61], v[130:131], v[242:243]
v_pk_mul_f32 v[62:63], v[146:147], v[242:243]
v_pk_mul_f32 v[130:131], v[130:131], v[226:227]
v_pk_mul_f32 v[146:147], v[146:147], v[226:227]
v_pk_fma_f32 v[130:131], v[162:163], v[242:243], v[130:131] neg_lo:[1,0,0] neg_hi:[1,0,0]
v_pk_fma_f32 v[146:147], v[178:179], v[242:243], v[146:147] neg_lo:[1,0,0] neg_hi:[1,0,0]
v_pk_fma_f32 v[162:163], v[162:163], v[226:227], v[60:61]
v_pk_fma_f32 v[178:179], v[178:179], v[226:227], v[62:63]
v_pk_add_f32 v[132:133], v[68:69], v[84:85]
v_pk_add_f32 v[148:149], v[68:69], v[84:85] neg_lo:[0,1] neg_hi:[0,1]
v_pk_add_f32 v[164:165], v[100:101], v[116:117]
v_pk_add_f32 v[180:181], v[100:101], v[116:117] neg_lo:[0,1] neg_hi:[0,1]
v_pk_mul_f32 v[60:61], v[132:133], v[244:245]
v_pk_mul_f32 v[62:63], v[148:149], v[244:245]
v_pk_mul_f32 v[132:133], v[132:133], v[228:229]
v_pk_mul_f32 v[148:149], v[148:149], v[228:229]
v_pk_fma_f32 v[132:133], v[164:165], v[244:245], v[132:133] neg_lo:[1,0,0] neg_hi:[1,0,0]
v_pk_fma_f32 v[148:149], v[180:181], v[244:245], v[148:149] neg_lo:[1,0,0] neg_hi:[1,0,0]
v_pk_fma_f32 v[164:165], v[164:165], v[228:229], v[60:61]
v_pk_fma_f32 v[180:181], v[180:181], v[228:229], v[62:63]
v_pk_add_f32 v[134:135], v[70:71], v[86:87]
v_pk_add_f32 v[150:151], v[70:71], v[86:87] neg_lo:[0,1] neg_hi:[0,1]
v_pk_add_f32 v[166:167], v[102:103], v[118:119]
v_pk_add_f32 v[182:183], v[102:103], v[118:119] neg_lo:[0,1] neg_hi:[0,1]
v_pk_mul_f32 v[60:61], v[134:135], v[246:247]
v_pk_mul_f32 v[62:63], v[150:151], v[246:247]
v_pk_mul_f32 v[134:135], v[134:135], v[230:231]
v_pk_mul_f32 v[150:151], v[150:151], v[230:231]
v_pk_fma_f32 v[134:135], v[166:167], v[246:247], v[134:135] neg_lo:[1,0,0] neg_hi:[1,0,0]
v_pk_fma_f32 v[150:151], v[182:183], v[246:247], v[150:151] neg_lo:[1,0,0] neg_hi:[1,0,0]
v_pk_fma_f32 v[166:167], v[166:167], v[230:231], v[60:61]
v_pk_fma_f32 v[182:183], v[182:183], v[230:231], v[62:63]
v_pk_add_f32 v[136:137], v[72:73], v[88:89]
v_pk_add_f32 v[152:153], v[72:73], v[88:89] neg_lo:[0,1] neg_hi:[0,1]
v_pk_add_f32 v[168:169], v[104:105], v[120:121]
v_pk_add_f32 v[184:185], v[104:105], v[120:121] neg_lo:[0,1] neg_hi:[0,1]
v_pk_mul_f32 v[60:61], v[136:137], v[248:249]
v_pk_mul_f32 v[62:63], v[152:153], v[248:249]
v_pk_mul_f32 v[136:137], v[136:137], v[232:233]
v_pk_mul_f32 v[152:153], v[152:153], v[232:233]
v_pk_fma_f32 v[136:137], v[168:169], v[248:249], v[136:137] neg_lo:[1,0,0] neg_hi:[1,0,0]
v_pk_fma_f32 v[152:153], v[184:185], v[248:249], v[152:153] neg_lo:[1,0,0] neg_hi:[1,0,0]
v_pk_fma_f32 v[168:169], v[168:169], v[232:233], v[60:61]
v_pk_fma_f32 v[184:185], v[184:185], v[232:233], v[62:63]
v_pk_add_f32 v[138:139], v[74:75], v[90:91]
v_pk_add_f32 v[154:155], v[74:75], v[90:91] neg_lo:[0,1] neg_hi:[0,1]
v_pk_add_f32 v[170:171], v[106:107], v[122:123]
v_pk_add_f32 v[186:187], v[106:107], v[122:123] neg_lo:[0,1] neg_hi:[0,1]
v_pk_mul_f32 v[60:61], v[138:139], v[250:251]
v_pk_mul_f32 v[62:63], v[154:155], v[250:251]
v_pk_mul_f32 v[138:139], v[138:139], v[234:235]
v_pk_mul_f32 v[154:155], v[154:155], v[234:235]
v_pk_fma_f32 v[138:139], v[170:171], v[250:251], v[138:139] neg_lo:[1,0,0] neg_hi:[1,0,0]
v_pk_fma_f32 v[154:155], v[186:187], v[250:251], v[154:155] neg_lo:[1,0,0] neg_hi:[1,0,0]
v_pk_fma_f32 v[170:171], v[170:171], v[234:235], v[60:61]
v_pk_fma_f32 v[186:187], v[186:187], v[234:235], v[62:63]
v_pk_add_f32 v[140:141], v[76:77], v[92:93]
v_pk_add_f32 v[156:157], v[76:77], v[92:93] neg_lo:[0,1] neg_hi:[0,1]
v_pk_add_f32 v[172:173], v[108:109], v[124:125]
v_pk_add_f32 v[188:189], v[108:109], v[124:125] neg_lo:[0,1] neg_hi:[0,1]
v_pk_mul_f32 v[60:61], v[140:141], v[252:253]
v_pk_mul_f32 v[62:63], v[156:157], v[252:253]
v_pk_mul_f32 v[140:141], v[140:141], v[236:237]
v_pk_mul_f32 v[156:157], v[156:157], v[236:237]
v_pk_fma_f32 v[140:141], v[172:173], v[252:253], v[140:141] neg_lo:[1,0,0] neg_hi:[1,0,0]
v_pk_fma_f32 v[156:157], v[188:189], v[252:253], v[156:157] neg_lo:[1,0,0] neg_hi:[1,0,0]
v_pk_fma_f32 v[172:173], v[172:173], v[236:237], v[60:61]
v_pk_fma_f32 v[188:189], v[188:189], v[236:237], v[62:63]
v_pk_add_f32 v[142:143], v[78:79], v[94:95]
v_pk_add_f32 v[158:159], v[78:79], v[94:95] neg_lo:[0,1] neg_hi:[0,1]
v_pk_add_f32 v[174:175], v[110:111], v[126:127]
v_pk_add_f32 v[190:191], v[110:111], v[126:127] neg_lo:[0,1] neg_hi:[0,1]
v_pk_mul_f32 v[60:61], v[142:143], v[254:255]
v_pk_mul_f32 v[62:63], v[158:159], v[254:255]
v_pk_mul_f32 v[142:143], v[142:143], v[238:239]
v_pk_mul_f32 v[158:159], v[158:159], v[238:239]
v_pk_fma_f32 v[142:143], v[174:175], v[254:255], v[142:143] neg_lo:[1,0,0] neg_hi:[1,0,0]
v_pk_fma_f32 v[158:159], v[190:191], v[254:255], v[158:159] neg_lo:[1,0,0] neg_hi:[1,0,0]
v_pk_fma_f32 v[174:175], v[174:175], v[238:239], v[60:61]
v_pk_fma_f32 v[190:191], v[190:191], v[238:239], v[62:63]
v_cvt_pk_bf16_f32 v192, v128, v129
v_cvt_pk_bf16_f32 v193, v130, v131
v_cvt_pk_bf16_f32 v194, v132, v133
v_cvt_pk_bf16_f32 v195, v134, v135
v_cvt_pk_bf16_f32 v196, v136, v137
v_cvt_pk_bf16_f32 v197, v138, v139
v_cvt_pk_bf16_f32 v198, v140, v141
v_cvt_pk_bf16_f32 v199, v142, v143
v_cvt_pk_bf16_f32 v200, v160, v161
v_cvt_pk_bf16_f32 v201, v162, v163
v_cvt_pk_bf16_f32 v202, v164, v165
v_cvt_pk_bf16_f32 v203, v166, v167
v_cvt_pk_bf16_f32 v204, v168, v169
v_cvt_pk_bf16_f32 v205, v170, v171
v_cvt_pk_bf16_f32 v206, v172, v173
v_cvt_pk_bf16_f32 v207, v174, v175
s_waitcnt lgkmcnt(0)
v_mfma_f32_32x32x16_bf16 v[64:79], v[192:195], v[8:11], 0
v_cvt_pk_bf16_f32 v208, v144, v145
v_cvt_pk_bf16_f32 v209, v146, v147
v_cvt_pk_bf16_f32 v210, v148, v149
v_cvt_pk_bf16_f32 v211, v150, v151
v_cvt_pk_bf16_f32 v212, v152, v153
v_cvt_pk_bf16_f32 v213, v154, v155
v_cvt_pk_bf16_f32 v214, v156, v157
v_cvt_pk_bf16_f32 v215, v158, v159
v_mfma_f32_32x32x16_bf16 v[64:79], v[196:199], v[12:15], v[64:79]
v_cvt_pk_bf16_f32 v216, v176, v177
v_cvt_pk_bf16_f32 v217, v178, v179
v_cvt_pk_bf16_f32 v218, v180, v181
v_cvt_pk_bf16_f32 v219, v182, v183
v_cvt_pk_bf16_f32 v220, v184, v185
v_cvt_pk_bf16_f32 v221, v186, v187
v_cvt_pk_bf16_f32 v222, v188, v189
v_mfma_f32_32x32x16_bf16 v[64:79], v[200:203], v[24:27], v[64:79]
v_cvt_pk_bf16_f32 v223, v190, v191
v_xor_b32 v48, 0x80008000, v40
v_xor_b32 v49, 0x80008000, v41
v_xor_b32 v50, 0x80008000, v42
v_xor_b32 v51, 0x80008000, v43
v_xor_b32 v52, 0x80008000, v44
v_xor_b32 v53, 0x80008000, v45
v_xor_b32 v54, 0x80008000, v46
v_mfma_f32_32x32x16_bf16 v[64:79], v[204:207], v[28:31], v[64:79]
v_xor_b32 v55, 0x80008000, v47
s_and_b32 s60, s20, 1
s_lshl_b32 s60, s60, 2
v_lshrrev_b32 v5, 5, v1
v_or_b32 v5, s60, v5
v_and_b32 v6, 7, v1
v_xor_b32 v5, v5, v6
v_mfma_f32_32x32x16_bf16 v[96:111], v[200:203], v[8:11], 0
v_lshlrev_b32 v5, 4, v5
v_lshl_add_u32 v5, v3, 11, v5
s_lshr_b32 s60, s20, 1
s_lshl_b32 s60, s60, 7
s_add_u32 s60, s60, 0
v_add_u32 v56, s60, v5
v_xor_b32 v57, 32, v56
v_bfe_u32 v5, v1, 2, 1
v_mfma_f32_32x32x16_bf16 v[96:111], v[204:207], v[12:15], v[96:111]
v_lshlrev_b32 v5, 2, v5
v_bfe_u32 v6, v1, 4, 1
v_lshl_add_u32 v5, v6, 1, v5
v_bfe_u32 v6, v1, 1, 1
v_add_u32 v5, v5, v6
v_xor_b32 v5, s20, v5
v_lshlrev_b32 v5, 4, v5
v_mfma_f32_32x32x16_bf16 v[96:111], v[192:195], v[16:19], v[96:111]
v_and_b32 v6, 1, v1
v_lshl_add_u32 v5, v6, 3, v5
v_bfe_u32 v6, v1, 3, 1
v_lshl_add_u32 v5, v6, 7, v5
v_lshrrev_b32 v6, 5, v1
v_lshl_add_u32 v5, v6, 9, v5
s_lshl_b32 s60, s20, 11
s_add_u32 s60, s60, 0
v_mfma_f32_32x32x16_bf16 v[96:111], v[196:199], v[20:23], v[96:111]
v_add_u32 v5, s60, v5
v_and_b32 v6, 15, v1
v_lshlrev_b32 v6, 4, v6
v_lshrrev_b32 v7, 5, v1
v_lshl_add_u32 v6, v7, 8, v6
v_bfe_u32 v7, v1, 4, 1
v_lshl_add_u32 v6, v7, 14, v6
v_mfma_f32_32x32x16_bf16 v[80:95], v[208:211], v[32:35], 0
v_mfma_f32_32x32x16_bf16 v[80:95], v[212:215], v[36:39], v[80:95]
v_cvt_pk_bf16_f32 v192, v64, v65
v_cvt_pk_bf16_f32 v193, v66, v67
v_cvt_pk_bf16_f32 v194, v68, v69
v_mfma_f32_32x32x16_bf16 v[80:95], v[216:219], v[48:51], v[80:95]
v_cvt_pk_bf16_f32 v195, v70, v71
v_cvt_pk_bf16_f32 v196, v72, v73
v_cvt_pk_bf16_f32 v197, v74, v75
v_mfma_f32_32x32x16_bf16 v[80:95], v[220:223], v[52:55], v[80:95]
v_cvt_pk_bf16_f32 v198, v76, v77
v_cvt_pk_bf16_f32 v199, v78, v79
v_cvt_pk_bf16_f32 v200, v96, v97
v_mfma_f32_32x32x16_bf16 v[112:127], v[216:219], v[32:35], 0
v_cvt_pk_bf16_f32 v201, v98, v99
v_cvt_pk_bf16_f32 v202, v100, v101
v_cvt_pk_bf16_f32 v203, v102, v103
v_mfma_f32_32x32x16_bf16 v[112:127], v[220:223], v[36:39], v[112:127]
v_cvt_pk_bf16_f32 v204, v104, v105
v_cvt_pk_bf16_f32 v205, v106, v107
v_cvt_pk_bf16_f32 v206, v108, v109
v_mfma_f32_32x32x16_bf16 v[112:127], v[208:211], v[40:43], v[112:127]
v_cvt_pk_bf16_f32 v207, v110, v111
ds_write_b128 v56, v[192:195] offset:0
ds_write_b128 v57, v[196:199] offset:0
v_mfma_f32_32x32x16_bf16 v[112:127], v[212:215], v[44:47], v[112:127]
ds_write_b128 v56, v[200:203] offset:512
ds_write_b128 v57, v[204:207] offset:512
s_waitcnt lgkmcnt(0)
s_barrier
ds_read_b64_tr_b16 v[128:129], v5 offset:0
ds_read_b64_tr_b16 v[130:131], v5 offset:256
ds_read_b64_tr_b16 v[132:133], v5 offset:16384
ds_read_b64_tr_b16 v[134:135], v5 offset:16640
ds_read_b64_tr_b16 v[136:137], v5 offset:32768
ds_read_b64_tr_b16 v[138:139], v5 offset:33024
ds_read_b64_tr_b16 v[140:141], v5 offset:49152
ds_read_b64_tr_b16 v[142:143], v5 offset:49408
s_waitcnt lgkmcnt(6)
buffer_store_dwordx4 v[128:131], v6, s[4:7], s47 offen sc1
s_add_u32 s47, s47, 524288
s_waitcnt lgkmcnt(4)
buffer_store_dwordx4 v[132:135], v6, s[4:7], s47 offen sc1
s_add_u32 s47, s47, 524288
s_waitcnt lgkmcnt(2)
buffer_store_dwordx4 v[136:139], v6, s[4:7], s47 offen sc1
s_add_u32 s47, s47, 524288
s_waitcnt lgkmcnt(0)
buffer_store_dwordx4 v[140:143], v6, s[4:7], s47 offen sc1
s_add_u32 s47, s47, 4293427200
v_cvt_pk_bf16_f32 v208, v80, v81
v_cvt_pk_bf16_f32 v209, v82, v83
v_cvt_pk_bf16_f32 v210, v84, v85
v_cvt_pk_bf16_f32 v211, v86, v87
v_cvt_pk_bf16_f32 v212, v88, v89
v_cvt_pk_bf16_f32 v213, v90, v91
v_cvt_pk_bf16_f32 v214, v92, v93
v_cvt_pk_bf16_f32 v215, v94, v95
v_cvt_pk_bf16_f32 v216, v112, v113
v_cvt_pk_bf16_f32 v217, v114, v115
v_cvt_pk_bf16_f32 v218, v116, v117
v_cvt_pk_bf16_f32 v219, v118, v119
v_cvt_pk_bf16_f32 v220, v120, v121
v_cvt_pk_bf16_f32 v221, v122, v123
v_cvt_pk_bf16_f32 v222, v124, v125
v_cvt_pk_bf16_f32 v223, v126, v127
ds_write_b128 v56, v[208:211] offset:1024
ds_write_b128 v57, v[212:215] offset:1024
ds_write_b128 v56, v[216:219] offset:1536
ds_write_b128 v57, v[220:223] offset:1536
s_waitcnt lgkmcnt(0)
s_barrier
ds_read_b64_tr_b16 v[144:145], v5 offset:1024
ds_read_b64_tr_b16 v[146:147], v5 offset:1280
ds_read_b64_tr_b16 v[148:149], v5 offset:17408
ds_read_b64_tr_b16 v[150:151], v5 offset:17664
ds_read_b64_tr_b16 v[152:153], v5 offset:33792
ds_read_b64_tr_b16 v[154:155], v5 offset:34048
ds_read_b64_tr_b16 v[156:157], v5 offset:50176
ds_read_b64_tr_b16 v[158:159], v5 offset:50432
s_waitcnt lgkmcnt(6)
buffer_store_dwordx4 v[144:147], v6, s[4:7], s47 offen sc1
s_add_u32 s47, s47, 524288
s_waitcnt lgkmcnt(4)
buffer_store_dwordx4 v[148:151], v6, s[4:7], s47 offen sc1
s_add_u32 s47, s47, 524288
s_waitcnt lgkmcnt(2)
buffer_store_dwordx4 v[152:155], v6, s[4:7], s47 offen sc1
s_add_u32 s47, s47, 524288
s_waitcnt lgkmcnt(0)
buffer_store_dwordx4 v[156:159], v6, s[4:7], s47 offen sc1
s_add_u32 s47, s47, 4293427200
v_mov_b32 v13, v58
v_mov_b32 v244, v59
s_waitcnt vmcnt(0)
s_barrier
s_cmp_lg_u32 s20, 0
s_cbranch_scc1 L_fl_31
v_mov_b32 v16, s22
v_lshlrev_b32 v17, 2, v1
s_mov_b32 exec_hi, 0
buffer_store_dword v16, v17, s[4:7], s57 offen sc1
s_mov_b64 exec, -1
L_fl_31:
s_add_u32 m0, s55, 0
s_add_u32 s52, s51, 0
buffer_load_dwordx4 v13, s[12:15], s52 offen lds
s_add_u32 m0, s55, 1024
s_add_u32 s52, s51, 8192
buffer_load_dwordx4 v13, s[12:15], s52 offen lds
s_add_u32 m0, s55, 2048
s_add_u32 s52, s51, 16384
buffer_load_dwordx4 v13, s[12:15], s52 offen lds
s_add_u32 m0, s55, 3072
s_add_u32 s52, s51, 24576
buffer_load_dwordx4 v13, s[12:15], s52 offen lds
s_add_u32 m0, s55, 32768
s_add_u32 s52, s51, 131072
buffer_load_dwordx4 v13, s[12:15], s52 offen lds
s_add_u32 m0, s55, 33792
s_add_u32 s52, s51, 139264
buffer_load_dwordx4 v13, s[12:15], s52 offen lds
s_add_u32 m0, s55, 34816
s_add_u32 s52, s51, 147456
buffer_load_dwordx4 v13, s[12:15], s52 offen lds
s_add_u32 m0, s55, 35840
s_add_u32 s52, s51, 155648
buffer_load_dwordx4 v13, s[12:15], s52 offen lds
s_add_u32 m0, s55, 65536
s_add_u32 s52, s51, 262144
buffer_load_dwordx4 v13, s[12:15], s52 offen lds
s_add_u32 m0, s55, 66560
s_add_u32 s52, s51, 270336
buffer_load_dwordx4 v13, s[12:15], s52 offen lds
s_add_u32 m0, s55, 67584
s_add_u32 s52, s51, 278528
buffer_load_dwordx4 v13, s[12:15], s52 offen lds
s_add_u32 m0, s55, 68608
s_add_u32 s52, s51, 286720
buffer_load_dwordx4 v13, s[12:15], s52 offen lds
s_add_u32 m0, s55, 98304
s_add_u32 s52, s51, 393216
buffer_load_dwordx4 v13, s[12:15], s52 offen lds
s_add_u32 m0, s55, 99328
s_add_u32 s52, s51, 401408
buffer_load_dwordx4 v13, s[12:15], s52 offen lds
s_add_u32 m0, s55, 100352
s_add_u32 s52, s51, 409600
buffer_load_dwordx4 v13, s[12:15], s52 offen lds
s_add_u32 m0, s55, 101376
s_add_u32 s52, s51, 417792
buffer_load_dwordx4 v13, s[12:15], s52 offen lds
s_add_u32 m0, s55, 131072
s_add_u32 s52, s51, 524288
buffer_load_dwordx4 v13, s[12:15], s52 offen lds
s_add_u32 m0, s55, 132096
s_add_u32 s52, s51, 532480
buffer_load_dwordx4 v13, s[12:15], s52 offen lds
s_add_u32 m0, s55, 133120
s_add_u32 s52, s51, 540672
buffer_load_dwordx4 v13, s[12:15], s52 offen lds
s_add_u32 m0, s55, 134144
s_add_u32 s52, s51, 548864
buffer_load_dwordx4 v13, s[12:15], s52 offen lds
s_mov_b32 s63, 1
L_g2:
s_mov_b32 s8, s24
s_and_b32 s9, s25, 0xffff
s_mov_b32 s10, 2097152
s_mov_b32 s11, 0x00020000
s_mov_b32 s16, s38
s_and_b32 s17, s39, 0xffff
s_mov_b32 s18, 2097152
s_mov_b32 s19, 0x00020000
v_lshlrev_b32 v3, 4, v1
s_mul_i32 s54, s50, 57344
s_mul_i32 s46, s49, 28672
s_add_u32 s54, s54, s46
s_add_u32 s54, s54, 10485760
s_lshl_b32 s57, s50, 14
s_lshl_b32 s46, s49, 13
s_add_u32 s57, s57, s46
s_add_u32 s57, s57, 8388608
v_lshrrev_b32 v6, 5, v1
v_lshlrev_b32 v6, 4, v6
v_bfe_u32 v7, v1, 4, 1
v_lshl_add_u32 v6, v7, 2, v6
v_bfe_u32 v4, v1, 2, 2
v_add_u32 v6, v6, v4
v_lshlrev_b32 v6, 7, v6
v_lshrrev_b32 v4, 1, v4
v_lshl_or_b32 v4, v7, 1, v4
v_lshl_add_u32 v6, v4, 5, v6
v_and_b32 v4, 3, v1
v_lshl_add_u32 v6, v4, 3, v6
s_lshl_b32 s46, s49, 14
v_add_u32 v164, s46, v6
v_xor_b32 v165, 32, v164
v_xor_b32 v166, 64, v164
v_xor_b32 v167, 96, v164
v_add_u32 v160, 0x10000, v164
v_add_u32 v180, 0x20000, v164
v_add_u32 v161, 0x10000, v165
v_add_u32 v181, 0x20000, v165
v_add_u32 v162, 0x10000, v166
v_add_u32 v182, 0x20000, v166
v_add_u32 v163, 0x10000, v167
v_add_u32 v183, 0x20000, v167
s_lshl_b32 s46, s49, 14
s_add_u32 s46, s46, 0x10000
v_add_u32 v173, s46, v3
s_lshl_b32 s58, s45, 16
s_lshl_b32 s46, s49, 15
s_add_u32 s58, s58, s46
s_lshl_b32 s46, s48, 12
s_add_u32 s58, s58, s46
s_add_u32 s58, s58, 7340032
v_min_u32 v170, 27, v1
v_lshlrev_b32 v170, 7, v170
v_and_b32 v172, 3, v1
v_lshlrev_b32 v172, 7, v172
s_lshr_b32 s59, s44, 2
s_lshl_b32 s59, s59, 12
s_add_u32 s59, s59, 69632
s_lshl_b32 s47, s20, 9
s_add_u32 s47, s47, 102400
s_cmp_lg_u32 s20, 0
s_cbranch_scc1 L_g2_np_32
s_waitcnt vmcnt(0)
s_mov_b32 s69, 0
L_poll_33:
buffer_load_dword v177, v170, s[4:7], s59 offen sc1
s_waitcnt vmcnt(0)
v_xor_b32 v177, s22, v177
v_cmp_ne_u32 vcc, 0, v177
    s_nop 0
s_cmp_eq_u64 vcc, 0
s_cbranch_scc1 L_pollx_34
s_add_u32 s69, s69, 1
s_cmp_lt_u32 s69, 0x200000
s_cbranch_scc1 L_poll_33
L_pollx_34:
L_g2_np_32:
s_barrier
buffer_load_dwordx4 v[64:67], v3, s[4:7], s54 offen offset:0 sc1
buffer_load_dwordx4 v[68:71], v3, s[4:7], s54 offen offset:1024 sc1
buffer_load_dwordx4 v[72:75], v3, s[4:7], s54 offen offset:2048 sc1
buffer_load_dwordx4 v[76:79], v3, s[4:7], s54 offen offset:3072 sc1
s_add_u32 s54, s54, 4096
s_barrier
buffer_load_dwordx4 v[80:83], v3, s[4:7], s54 offen offset:0 sc1
buffer_load_dwordx4 v[84:87], v3, s[4:7], s54 offen offset:1024 sc1
buffer_load_dwordx4 v[88:91], v3, s[4:7], s54 offen offset:2048 sc1
buffer_load_dwordx4 v[92:95], v3, s[4:7], s54 offen offset:3072 sc1
s_add_u32 s54, s54, 4096
s_lshl_b32 s46, s20, 12
s_add_u32 s46, s46, 131072
v_add_u32 v6, s46, v3
v_xor_b32 v7, 0x4000, v6
s_waitcnt vmcnt(4)
s_barrier
ds_read_b64_tr_b16 v[128:129], v164 offset:0
ds_read_b64_tr_b16 v[130:131], v164 offset:1024
ds_read_b64_tr_b16 v[132:133], v165 offset:0
ds_read_b64_tr_b16 v[134:135], v165 offset:1024
ds_read_b64_tr_b16 v[136:137], v166 offset:0
ds_read_b64_tr_b16 v[138:139], v166 offset:1024
ds_read_b64_tr_b16 v[140:141], v167 offset:0
ds_read_b64_tr_b16 v[142:143], v167 offset:1024
s_waitcnt lgkmcnt(4)
v_mfma_f32_16x16x32_bf16 v[16:19], v[128:131], v[64:67], 0
ds_read_b64_tr_b16 v[144:145], v164 offset:4096
ds_read_b64_tr_b16 v[146:147], v164 offset:5120
buffer_load_dwordx4 v[96:99], v3, s[4:7], s54 offen offset:0 sc1
v_mfma_f32_16x16x32_bf16 v[20:23], v[132:135], v[64:67], 0
ds_read_b64_tr_b16 v[148:149], v165 offset:4096
ds_read_b64_tr_b16 v[150:151], v165 offset:5120
s_waitcnt lgkmcnt(4)
v_mfma_f32_16x16x32_bf16 v[24:27], v[136:139], v[64:67], 0
ds_read_b64_tr_b16 v[152:153], v166 offset:4096
ds_read_b64_tr_b16 v[154:155], v166 offset:5120
buffer_load_dwordx4 v[100:103], v3, s[4:7], s54 offen offset:1024 sc1
v_mfma_f32_16x16x32_bf16 v[28:31], v[140:143], v[64:67], 0
ds_read_b64_tr_b16 v[156:157], v167 offset:4096
ds_read_b64_tr_b16 v[158:159], v167 offset:5120
s_waitcnt lgkmcnt(4)
v_mfma_f32_16x16x32_bf16 v[16:19], v[144:147], v[68:71], v[16:19]
ds_read_b64_tr_b16 v[128:129], v164 offset:8192
ds_read_b64_tr_b16 v[130:131], v164 offset:9216
buffer_load_dwordx4 v[104:107], v3, s[4:7], s54 offen offset:2048 sc1
v_mfma_f32_16x16x32_bf16 v[20:23], v[148:151], v[68:71], v[20:23]
ds_read_b64_tr_b16 v[132:133], v165 offset:8192
ds_read_b64_tr_b16 v[134:135], v165 offset:9216
s_waitcnt lgkmcnt(4)
v_mfma_f32_16x16x32_bf16 v[24:27], v[152:155], v[68:71], v[24:27]
ds_read_b64_tr_b16 v[136:137], v166 offset:8192
ds_read_b64_tr_b16 v[138:139], v166 offset:9216
buffer_load_dwordx4 v[108:111], v3, s[4:7], s54 offen offset:3072 sc1
s_add_u32 s54, s54, 4096
v_mfma_f32_16x16x32_bf16 v[28:31], v[156:159], v[68:71], v[28:31]
ds_read_b64_tr_b16 v[140:141], v167 offset:8192
ds_read_b64_tr_b16 v[142:143], v167 offset:9216
s_waitcnt lgkmcnt(4)
v_mfma_f32_16x16x32_bf16 v[16:19], v[128:131], v[72:75], v[16:19]
ds_read_b64_tr_b16 v[144:145], v164 offset:12288
ds_read_b64_tr_b16 v[146:147], v164 offset:13312
v_mfma_f32_16x16x32_bf16 v[20:23], v[132:135], v[72:75], v[20:23]
ds_read_b64_tr_b16 v[148:149], v165 offset:12288
ds_read_b64_tr_b16 v[150:151], v165 offset:13312
s_waitcnt lgkmcnt(4)
v_mfma_f32_16x16x32_bf16 v[24:27], v[136:139], v[72:75], v[24:27]
ds_read_b64_tr_b16 v[152:153], v166 offset:12288
ds_read_b64_tr_b16 v[154:155], v166 offset:13312
v_mfma_f32_16x16x32_bf16 v[28:31], v[140:143], v[72:75], v[28:31]
ds_read_b64_tr_b16 v[156:157], v167 offset:12288
ds_read_b64_tr_b16 v[158:159], v167 offset:13312
s_waitcnt lgkmcnt(4)
v_mfma_f32_16x16x32_bf16 v[16:19], v[144:147], v[76:79], v[16:19]
v_mfma_f32_16x16x32_bf16 v[20:23], v[148:151], v[76:79], v[20:23]
s_waitcnt lgkmcnt(0)
v_mfma_f32_16x16x32_bf16 v[24:27], v[152:155], v[76:79], v[24:27]
v_mfma_f32_16x16x32_bf16 v[28:31], v[156:159], v[76:79], v[28:31]
s_waitcnt vmcnt(4)
s_barrier
ds_read_b64_tr_b16 v[128:129], v164 offset:32768
ds_read_b64_tr_b16 v[130:131], v164 offset:33792
ds_read_b64_tr_b16 v[132:133], v165 offset:32768
ds_read_b64_tr_b16 v[134:135], v165 offset:33792
ds_read_b64_tr_b16 v[136:137], v166 offset:32768
ds_read_b64_tr_b16 v[138:139], v166 offset:33792
ds_read_b64_tr_b16 v[140:141], v167 offset:32768
ds_read_b64_tr_b16 v[142:143], v167 offset:33792
s_waitcnt lgkmcnt(4)
v_mfma_f32_16x16x32_bf16 v[16:19], v[128:131], v[80:83], v[16:19]
ds_read_b64_tr_b16 v[144:145], v164 offset:36864
ds_read_b64_tr_b16 v[146:147], v164 offset:37888
buffer_load_dwordx4 v[112:115], v3, s[4:7], s54 offen offset:0 sc1
v_mfma_f32_16x16x32_bf16 v[20:23], v[132:135], v[80:83], v[20:23]
ds_read_b64_tr_b16 v[148:149], v165 offset:36864
ds_read_b64_tr_b16 v[150:151], v165 offset:37888
s_waitcnt lgkmcnt(4)
v_mfma_f32_16x16x32_bf16 v[24:27], v[136:139], v[80:83], v[24:27]
ds_read_b64_tr_b16 v[152:153], v166 offset:36864
ds_read_b64_tr_b16 v[154:155], v166 offset:37888
buffer_load_dwordx4 v[116:119], v3, s[4:7], s54 offen offset:1024 sc1
v_mfma_f32_16x16x32_bf16 v[28:31], v[140:143], v[80:83], v[28:31]
ds_read_b64_tr_b16 v[156:157], v167 offset:36864
ds_read_b64_tr_b16 v[158:159], v167 offset:37888
s_waitcnt lgkmcnt(4)
v_mfma_f32_16x16x32_bf16 v[16:19], v[144:147], v[84:87], v[16:19]
ds_read_b64_tr_b16 v[128:129], v164 offset:40960
ds_read_b64_tr_b16 v[130:131], v164 offset:41984
buffer_load_dwordx4 v[120:123], v3, s[4:7], s54 offen offset:2048 sc1
v_mfma_f32_16x16x32_bf16 v[20:23], v[148:151], v[84:87], v[20:23]
ds_read_b64_tr_b16 v[132:133], v165 offset:40960
ds_read_b64_tr_b16 v[134:135], v165 offset:41984
s_waitcnt lgkmcnt(4)
v_mfma_f32_16x16x32_bf16 v[24:27], v[152:155], v[84:87], v[24:27]
ds_read_b64_tr_b16 v[136:137], v166 offset:40960
ds_read_b64_tr_b16 v[138:139], v166 offset:41984
buffer_load_dwordx4 v[124:127], v3, s[4:7], s54 offen offset:3072 sc1
s_add_u32 s54, s54, 4096
v_mfma_f32_16x16x32_bf16 v[28:31], v[156:159], v[84:87], v[28:31]
ds_read_b64_tr_b16 v[140:141], v167 offset:40960
ds_read_b64_tr_b16 v[142:143], v167 offset:41984
s_waitcnt lgkmcnt(4)
v_mfma_f32_16x16x32_bf16 v[16:19], v[128:131], v[88:91], v[16:19]
ds_read_b64_tr_b16 v[144:145], v164 offset:45056
ds_read_b64_tr_b16 v[146:147], v164 offset:46080
s_add_u32 m0, s55, 0
s_add_u32 s52, s51, 655360
buffer_load_dwordx4 v13, s[12:15], s52 offen lds
v_mfma_f32_16x16x32_bf16 v[20:23], v[132:135], v[88:91], v[20:23]
ds_read_b64_tr_b16 v[148:149], v165 offset:45056
ds_read_b64_tr_b16 v[150:151], v165 offset:46080
s_waitcnt lgkmcnt(4)
v_mfma_f32_16x16x32_bf16 v[24:27], v[136:139], v[88:91], v[24:27]
ds_read_b64_tr_b16 v[152:153], v166 offset:45056
ds_read_b64_tr_b16 v[154:155], v166 offset:46080
s_add_u32 m0, s55, 1024
s_add_u32 s52, s51, 663552
buffer_load_dwordx4 v13, s[12:15], s52 offen lds
v_mfma_f32_16x16x32_bf16 v[28:31], v[140:143], v[88:91], v[28:31]
ds_read_b64_tr_b16 v[156:157], v167 offset:45056
ds_read_b64_tr_b16 v[158:159], v167 offset:46080
s_waitcnt lgkmcnt(4)
v_mfma_f32_16x16x32_bf16 v[16:19], v[144:147], v[92:95], v[16:19]
v_mfma_f32_16x16x32_bf16 v[20:23], v[148:151], v[92:95], v[20:23]
s_waitcnt lgkmcnt(0)
v_mfma_f32_16x16x32_bf16 v[24:27], v[152:155], v[92:95], v[24:27]
v_mfma_f32_16x16x32_bf16 v[28:31], v[156:159], v[92:95], v[28:31]
s_waitcnt vmcnt(6)
s_barrier
ds_read_b64_tr_b16 v[128:129], v160 offset:0
ds_read_b64_tr_b16 v[130:131], v160 offset:1024
ds_read_b64_tr_b16 v[132:133], v161 offset:0
ds_read_b64_tr_b16 v[134:135], v161 offset:1024
ds_read_b64_tr_b16 v[136:137], v162 offset:0
ds_read_b64_tr_b16 v[138:139], v162 offset:1024
ds_read_b64_tr_b16 v[140:141], v163 offset:0
ds_read_b64_tr_b16 v[142:143], v163 offset:1024
s_waitcnt lgkmcnt(4)
v_mfma_f32_16x16x32_bf16 v[16:19], v[128:131], v[96:99], v[16:19]
ds_read_b64_tr_b16 v[144:145], v160 offset:4096
ds_read_b64_tr_b16 v[146:147], v160 offset:5120
buffer_load_dwordx4 v[64:67], v3, s[4:7], s54 offen offset:0 sc1
v_mfma_f32_16x16x32_bf16 v[20:23], v[132:135], v[96:99], v[20:23]
ds_read_b64_tr_b16 v[148:149], v161 offset:4096
ds_read_b64_tr_b16 v[150:151], v161 offset:5120
s_waitcnt lgkmcnt(4)
v_mfma_f32_16x16x32_bf16 v[24:27], v[136:139], v[96:99], v[24:27]
ds_read_b64_tr_b16 v[152:153], v162 offset:4096
ds_read_b64_tr_b16 v[154:155], v162 offset:5120
buffer_load_dwordx4 v[68:71], v3, s[4:7], s54 offen offset:1024 sc1
v_mfma_f32_16x16x32_bf16 v[28:31], v[140:143], v[96:99], v[28:31]
ds_read_b64_tr_b16 v[156:157], v163 offset:4096
ds_read_b64_tr_b16 v[158:159], v163 offset:5120
s_waitcnt lgkmcnt(4)
v_mfma_f32_16x16x32_bf16 v[16:19], v[144:147], v[100:103], v[16:19]
ds_read_b64_tr_b16 v[128:129], v160 offset:8192
ds_read_b64_tr_b16 v[130:131], v160 offset:9216
buffer_load_dwordx4 v[72:75], v3, s[4:7], s54 offen offset:2048 sc1
v_mfma_f32_16x16x32_bf16 v[20:23], v[148:151], v[100:103], v[20:23]
ds_read_b64_tr_b16 v[132:133], v161 offset:8192
ds_read_b64_tr_b16 v[134:135], v161 offset:9216
s_waitcnt lgkmcnt(4)
v_mfma_f32_16x16x32_bf16 v[24:27], v[152:155], v[100:103], v[24:27]
ds_read_b64_tr_b16 v[136:137], v162 offset:8192
ds_read_b64_tr_b16 v[138:139], v162 offset:9216
buffer_load_dwordx4 v[76:79], v3, s[4:7], s54 offen offset:3072 sc1
s_add_u32 s54, s54, 4096
v_mfma_f32_16x16x32_bf16 v[28:31], v[156:159], v[100:103], v[28:31]
ds_read_b64_tr_b16 v[140:141], v163 offset:8192
ds_read_b64_tr_b16 v[142:143], v163 offset:9216
s_waitcnt lgkmcnt(4)
v_mfma_f32_16x16x32_bf16 v[16:19], v[128:131], v[104:107], v[16:19]
ds_read_b64_tr_b16 v[144:145], v160 offset:12288
ds_read_b64_tr_b16 v[146:147], v160 offset:13312
s_add_u32 m0, s55, 2048
s_add_u32 s52, s51, 671744
buffer_load_dwordx4 v13, s[12:15], s52 offen lds
v_mfma_f32_16x16x32_bf16 v[20:23], v[132:135], v[104:107], v[20:23]
ds_read_b64_tr_b16 v[148:149], v161 offset:12288
ds_read_b64_tr_b16 v[150:151], v161 offset:13312
s_waitcnt lgkmcnt(4)
v_mfma_f32_16x16x32_bf16 v[24:27], v[136:139], v[104:107], v[24:27]
ds_read_b64_tr_b16 v[152:153], v162 offset:12288
ds_read_b64_tr_b16 v[154:155], v162 offset:13312
s_add_u32 m0, s55, 3072
s_add_u32 s52, s51, 679936
buffer_load_dwordx4 v13, s[12:15], s52 offen lds
v_mfma_f32_16x16x32_bf16 v[28:31], v[140:143], v[104:107], v[28:31]
ds_read_b64_tr_b16 v[156:157], v163 offset:12288
ds_read_b64_tr_b16 v[158:159], v163 offset:13312
s_waitcnt lgkmcnt(4)
v_mfma_f32_16x16x32_bf16 v[16:19], v[144:147], v[108:111], v[16:19]
s_add_u32 m0, s55, 32768
s_add_u32 s52, s51, 786432
buffer_load_dwordx4 v13, s[12:15], s52 offen lds
v_mfma_f32_16x16x32_bf16 v[20:23], v[148:151], v[108:111], v[20:23]
s_waitcnt lgkmcnt(0)
v_mfma_f32_16x16x32_bf16 v[24:27], v[152:155], v[108:111], v[24:27]
s_add_u32 m0, s55, 33792
s_add_u32 s52, s51, 794624
buffer_load_dwordx4 v13, s[12:15], s52 offen lds
v_mfma_f32_16x16x32_bf16 v[28:31], v[156:159], v[108:111], v[28:31]
s_waitcnt vmcnt(10)
s_barrier
ds_read_b64_tr_b16 v[128:129], v160 offset:32768
ds_read_b64_tr_b16 v[130:131], v160 offset:33792
ds_read_b64_tr_b16 v[132:133], v161 offset:32768
ds_read_b64_tr_b16 v[134:135], v161 offset:33792
ds_read_b64_tr_b16 v[136:137], v162 offset:32768
ds_read_b64_tr_b16 v[138:139], v162 offset:33792
ds_read_b64_tr_b16 v[140:141], v163 offset:32768
ds_read_b64_tr_b16 v[142:143], v163 offset:33792
s_waitcnt lgkmcnt(4)
v_mfma_f32_16x16x32_bf16 v[16:19], v[128:131], v[112:115], v[16:19]
ds_read_b64_tr_b16 v[144:145], v160 offset:36864
ds_read_b64_tr_b16 v[146:147], v160 offset:37888
buffer_load_dword v176, v172, s[4:7], s47 offen sc1
v_mfma_f32_16x16x32_bf16 v[20:23], v[132:135], v[112:115], v[20:23]
ds_read_b64_tr_b16 v[148:149], v161 offset:36864
ds_read_b64_tr_b16 v[150:151], v161 offset:37888
s_waitcnt lgkmcnt(4)
v_mfma_f32_16x16x32_bf16 v[24:27], v[136:139], v[112:115], v[24:27]
ds_read_b64_tr_b16 v[152:153], v162 offset:36864
ds_read_b64_tr_b16 v[154:155], v162 offset:37888
buffer_load_dwordx4 v[80:83], v3, s[4:7], s54 offen offset:0 sc1
v_mfma_f32_16x16x32_bf16 v[28:31], v[140:143], v[112:115], v[28:31]
ds_read_b64_tr_b16 v[156:157], v163 offset:36864
ds_read_b64_tr_b16 v[158:159], v163 offset:37888
s_waitcnt lgkmcnt(4)
v_mfma_f32_16x16x32_bf16 v[16:19], v[144:147], v[116:119], v[16:19]
ds_read_b64_tr_b16 v[128:129], v160 offset:40960
ds_read_b64_tr_b16 v[130:131], v160 offset:41984
buffer_load_dwordx4 v[84:87], v3, s[4:7], s54 offen offset:1024 sc1
v_mfma_f32_16x16x32_bf16 v[20:23], v[148:151], v[116:119], v[20:23]
ds_read_b64_tr_b16 v[132:133], v161 offset:40960
ds_read_b64_tr_b16 v[134:135], v161 offset:41984
s_waitcnt lgkmcnt(4)
v_mfma_f32_16x16x32_bf16 v[24:27], v[152:155], v[116:119], v[24:27]
ds_read_b64_tr_b16 v[136:137], v162 offset:40960
ds_read_b64_tr_b16 v[138:139], v162 offset:41984
buffer_load_dwordx4 v[88:91], v3, s[4:7], s54 offen offset:2048 sc1
v_mfma_f32_16x16x32_bf16 v[28:31], v[156:159], v[116:119], v[28:31]
ds_read_b64_tr_b16 v[140:141], v163 offset:40960
ds_read_b64_tr_b16 v[142:143], v163 offset:41984
s_waitcnt lgkmcnt(4)
v_mfma_f32_16x16x32_bf16 v[16:19], v[128:131], v[120:123], v[16:19]
ds_read_b64_tr_b16 v[144:145], v160 offset:45056
ds_read_b64_tr_b16 v[146:147], v160 offset:46080
buffer_load_dwordx4 v[92:95], v3, s[4:7], s54 offen offset:3072 sc1
s_add_u32 s54, s54, 4096
v_mfma_f32_16x16x32_bf16 v[20:23], v[132:135], v[120:123], v[20:23]
ds_read_b64_tr_b16 v[148:149], v161 offset:45056
ds_read_b64_tr_b16 v[150:151], v161 offset:46080
s_waitcnt lgkmcnt(4)
v_mfma_f32_16x16x32_bf16 v[24:27], v[136:139], v[120:123], v[24:27]
ds_read_b64_tr_b16 v[152:153], v162 offset:45056
ds_read_b64_tr_b16 v[154:155], v162 offset:46080
s_add_u32 m0, s55, 34816
s_add_u32 s52, s51, 802816
buffer_load_dwordx4 v13, s[12:15], s52 offen lds
v_mfma_f32_16x16x32_bf16 v[28:31], v[140:143], v[120:123], v[28:31]
ds_read_b64_tr_b16 v[156:157], v163 offset:45056
ds_read_b64_tr_b16 v[158:159], v163 offset:46080
s_waitcnt lgkmcnt(4)
v_mfma_f32_16x16x32_bf16 v[16:19], v[144:147], v[124:127], v[16:19]
s_add_u32 m0, s55, 35840
s_add_u32 s52, s51, 811008
buffer_load_dwordx4 v13, s[12:15], s52 offen lds
v_mfma_f32_16x16x32_bf16 v[20:23], v[148:151], v[124:127], v[20:23]
s_waitcnt lgkmcnt(0)
v_mfma_f32_16x16x32_bf16 v[24:27], v[152:155], v[124:127], v[24:27]
v_mfma_f32_16x16x32_bf16 v[28:31], v[156:159], v[124:127], v[28:31]
s_waitcnt vmcnt(6)
v_cmp_ne_u32 vcc, s22, v176
    s_nop 0
s_cmp_eq_u64 vcc, 0
s_cbranch_scc1 L_g2_ok_35
s_mov_b32 s69, 0
L_poll_36:
buffer_load_dword v176, v172, s[4:7], s47 offen sc1
s_waitcnt vmcnt(0)
v_xor_b32 v176, s22, v176
v_cmp_ne_u32 vcc, 0, v176
    s_nop 0
s_cmp_eq_u64 vcc, 0
s_cbranch_scc1 L_pollx_37
s_add_u32 s69, s69, 1
s_cmp_lt_u32 s69, 0x200000
s_cbranch_scc1 L_poll_36
L_pollx_37:
s_mov_b32 s67, 1
L_g2_ok_35:
s_barrier
ds_read_b64_tr_b16 v[128:129], v180 offset:0
ds_read_b64_tr_b16 v[130:131], v180 offset:1024
ds_read_b64_tr_b16 v[132:133], v181 offset:0
ds_read_b64_tr_b16 v[134:135], v181 offset:1024
ds_read_b64_tr_b16 v[136:137], v182 offset:0
ds_read_b64_tr_b16 v[138:139], v182 offset:1024
ds_read_b64_tr_b16 v[140:141], v183 offset:0
ds_read_b64_tr_b16 v[142:143], v183 offset:1024
s_waitcnt lgkmcnt(4)
v_mfma_f32_16x16x32_bf16 v[16:19], v[128:131], v[64:67], v[16:19]
ds_read_b64_tr_b16 v[144:145], v180 offset:4096
ds_read_b64_tr_b16 v[146:147], v180 offset:5120
buffer_load_dwordx4 v[96:99], v3, s[4:7], s54 offen offset:0 sc1
v_mfma_f32_16x16x32_bf16 v[20:23], v[132:135], v[64:67], v[20:23]
ds_read_b64_tr_b16 v[148:149], v181 offset:4096
ds_read_b64_tr_b16 v[150:151], v181 offset:5120
s_waitcnt lgkmcnt(4)
v_mfma_f32_16x16x32_bf16 v[24:27], v[136:139], v[64:67], v[24:27]
ds_read_b64_tr_b16 v[152:153], v182 offset:4096
ds_read_b64_tr_b16 v[154:155], v182 offset:5120
buffer_load_dwordx4 v[100:103], v3, s[4:7], s54 offen offset:1024 sc1
v_mfma_f32_16x16x32_bf16 v[28:31], v[140:143], v[64:67], v[28:31]
ds_read_b64_tr_b16 v[156:157], v183 offset:4096
ds_read_b64_tr_b16 v[158:159], v183 offset:5120
s_waitcnt lgkmcnt(4)
v_mfma_f32_16x16x32_bf16 v[16:19], v[144:147], v[68:71], v[16:19]
ds_read_b64_tr_b16 v[128:129], v180 offset:8192
ds_read_b64_tr_b16 v[130:131], v180 offset:9216
buffer_load_dwordx4 v[104:107], v3, s[4:7], s54 offen offset:2048 sc1
v_mfma_f32_16x16x32_bf16 v[20:23], v[148:151], v[68:71], v[20:23]
ds_read_b64_tr_b16 v[132:133], v181 offset:8192
ds_read_b64_tr_b16 v[134:135], v181 offset:9216
s_waitcnt lgkmcnt(4)
v_mfma_f32_16x16x32_bf16 v[24:27], v[152:155], v[68:71], v[24:27]
ds_read_b64_tr_b16 v[136:137], v182 offset:8192
ds_read_b64_tr_b16 v[138:139], v182 offset:9216
buffer_load_dwordx4 v[108:111], v3, s[4:7], s54 offen offset:3072 sc1
s_add_u32 s54, s54, 4096
v_mfma_f32_16x16x32_bf16 v[28:31], v[156:159], v[68:71], v[28:31]
ds_read_b64_tr_b16 v[140:141], v183 offset:8192
ds_read_b64_tr_b16 v[142:143], v183 offset:9216
s_waitcnt lgkmcnt(4)
v_mfma_f32_16x16x32_bf16 v[16:19], v[128:131], v[72:75], v[16:19]
ds_read_b64_tr_b16 v[144:145], v180 offset:12288
ds_read_b64_tr_b16 v[146:147], v180 offset:13312
s_add_u32 m0, s55, 65536
    s_nop 0
buffer_load_dwordx4 v2, s[4:7], s58 offen offset:0 sc1 lds
v_mfma_f32_16x16x32_bf16 v[20:23], v[132:135], v[72:75], v[20:23]
ds_read_b64_tr_b16 v[148:149], v181 offset:12288
ds_read_b64_tr_b16 v[150:151], v181 offset:13312
s_waitcnt lgkmcnt(4)
v_mfma_f32_16x16x32_bf16 v[24:27], v[136:139], v[72:75], v[24:27]
ds_read_b64_tr_b16 v[152:153], v182 offset:12288
ds_read_b64_tr_b16 v[154:155], v182 offset:13312
s_add_u32 m0, s55, 65536
    s_nop 0
buffer_load_dwordx4 v2, s[4:7], s58 offen offset:1024 sc1 lds
v_mfma_f32_16x16x32_bf16 v[28:31], v[140:143], v[72:75], v[28:31]
ds_read_b64_tr_b16 v[156:157], v183 offset:12288
ds_read_b64_tr_b16 v[158:159], v183 offset:13312
s_waitcnt lgkmcnt(4)
v_mfma_f32_16x16x32_bf16 v[16:19], v[144:147], v[76:79], v[16:19]
s_add_u32 m0, s55, 65536
    s_nop 0
buffer_load_dwordx4 v2, s[4:7], s58 offen offset:2048 sc1 lds
v_mfma_f32_16x16x32_bf16 v[20:23], v[148:151], v[76:79], v[20:23]
s_waitcnt lgkmcnt(0)
v_mfma_f32_16x16x32_bf16 v[24:27], v[152:155], v[76:79], v[24:27]
s_add_u32 m0, s55, 65536
    s_nop 0
buffer_load_dwordx4 v2, s[4:7], s58 offen offset:3072 sc1 lds
s_add_u32 s58, s58, 16384
v_mfma_f32_16x16x32_bf16 v[28:31], v[156:159], v[76:79], v[28:31]
s_waitcnt vmcnt(10)
s_barrier
ds_read_b64_tr_b16 v[128:129], v164 offset:0
ds_read_b64_tr_b16 v[130:131], v164 offset:1024
ds_read_b64_tr_b16 v[132:133], v165 offset:0
ds_read_b64_tr_b16 v[134:135], v165 offset:1024
ds_read_b64_tr_b16 v[136:137], v166 offset:0
ds_read_b64_tr_b16 v[138:139], v166 offset:1024
ds_read_b64_tr_b16 v[140:141], v167 offset:0
ds_read_b64_tr_b16 v[142:143], v167 offset:1024
s_waitcnt lgkmcnt(4)
v_mfma_f32_16x16x32_bf16 v[16:19], v[128:131], v[80:83], v[16:19]
ds_read_b64_tr_b16 v[144:145], v164 offset:4096
ds_read_b64_tr_b16 v[146:147], v164 offset:5120
s_mov_b32 s54, s57
buffer_load_dwordx4 v[112:115], v3, s[4:7], s54 offen offset:0 sc1
v_mfma_f32_16x16x32_bf16 v[20:23], v[132:135], v[80:83], v[20:23]
ds_read_b64_tr_b16 v[148:149], v165 offset:4096
ds_read_b64_tr_b16 v[150:151], v165 offset:5120
s_waitcnt lgkmcnt(4)
v_mfma_f32_16x16x32_bf16 v[24:27], v[136:139], v[80:83], v[24:27]
ds_read_b64_tr_b16 v[152:153], v166 offset:4096
ds_read_b64_tr_b16 v[154:155], v166 offset:5120
buffer_load_dwordx4 v[116:119], v3, s[4:7], s54 offen offset:1024 sc1
v_mfma_f32_16x16x32_bf16 v[28:31], v[140:143], v[80:83], v[28:31]
ds_read_b64_tr_b16 v[156:157], v167 offset:4096
ds_read_b64_tr_b16 v[158:159], v167 offset:5120
s_waitcnt lgkmcnt(4)
v_mfma_f32_16x16x32_bf16 v[16:19], v[144:147], v[84:87], v[16:19]
ds_read_b64_tr_b16 v[128:129], v164 offset:8192
ds_read_b64_tr_b16 v[130:131], v164 offset:9216
buffer_load_dwordx4 v[120:123], v3, s[4:7], s54 offen offset:2048 sc1
v_mfma_f32_16x16x32_bf16 v[20:23], v[148:151], v[84:87], v[20:23]
ds_read_b64_tr_b16 v[132:133], v165 offset:8192
ds_read_b64_tr_b16 v[134:135], v165 offset:9216
s_waitcnt lgkmcnt(4)
v_mfma_f32_16x16x32_bf16 v[24:27], v[152:155], v[84:87], v[24:27]
ds_read_b64_tr_b16 v[136:137], v166 offset:8192
ds_read_b64_tr_b16 v[138:139], v166 offset:9216
buffer_load_dwordx4 v[124:127], v3, s[4:7], s54 offen offset:3072 sc1
s_add_u32 s54, s54, 4096
v_mfma_f32_16x16x32_bf16 v[28:31], v[156:159], v[84:87], v[28:31]
ds_read_b64_tr_b16 v[140:141], v167 offset:8192
ds_read_b64_tr_b16 v[142:143], v167 offset:9216
s_waitcnt lgkmcnt(4)
v_mfma_f32_16x16x32_bf16 v[16:19], v[128:131], v[88:91], v[16:19]
ds_read_b64_tr_b16 v[144:145], v164 offset:12288
ds_read_b64_tr_b16 v[146:147], v164 offset:13312
s_add_u32 m0, s55, 98304
    s_nop 0
buffer_load_dwordx4 v2, s[4:7], s58 offen offset:0 sc1 lds
v_mfma_f32_16x16x32_bf16 v[20:23], v[132:135], v[88:91], v[20:23]
ds_read_b64_tr_b16 v[148:149], v165 offset:12288
ds_read_b64_tr_b16 v[150:151], v165 offset:13312
s_waitcnt lgkmcnt(4)
v_mfma_f32_16x16x32_bf16 v[24:27], v[136:139], v[88:91], v[24:27]
ds_read_b64_tr_b16 v[152:153], v166 offset:12288
ds_read_b64_tr_b16 v[154:155], v166 offset:13312
s_add_u32 m0, s55, 98304
    s_nop 0
buffer_load_dwordx4 v2, s[4:7], s58 offen offset:1024 sc1 lds
v_mfma_f32_16x16x32_bf16 v[28:31], v[140:143], v[88:91], v[28:31]
ds_read_b64_tr_b16 v[156:157], v167 offset:12288
ds_read_b64_tr_b16 v[158:159], v167 offset:13312
s_waitcnt lgkmcnt(4)
v_mfma_f32_16x16x32_bf16 v[16:19], v[144:147], v[92:95], v[16:19]
v_mfma_f32_16x16x32_bf16 v[20:23], v[148:151], v[92:95], v[20:23]
s_waitcnt lgkmcnt(0)
v_mfma_f32_16x16x32_bf16 v[24:27], v[152:155], v[92:95], v[24:27]
v_mfma_f32_16x16x32_bf16 v[28:31], v[156:159], v[92:95], v[28:31]
s_waitcnt vmcnt(10)
s_barrier
ds_read_b64_tr_b16 v[128:129], v164 offset:32768
ds_read_b64_tr_b16 v[130:131], v164 offset:33792
ds_read_b64_tr_b16 v[132:133], v165 offset:32768
ds_read_b64_tr_b16 v[134:135], v165 offset:33792
ds_read_b64_tr_b16 v[136:137], v166 offset:32768
ds_read_b64_tr_b16 v[138:139], v166 offset:33792
ds_read_b64_tr_b16 v[140:141], v167 offset:32768
ds_read_b64_tr_b16 v[142:143], v167 offset:33792
s_waitcnt lgkmcnt(4)
v_mfma_f32_16x16x32_bf16 v[16:19], v[128:131], v[96:99], v[16:19]
ds_read_b64_tr_b16 v[144:145], v164 offset:36864
ds_read_b64_tr_b16 v[146:147], v164 offset:37888
buffer_load_dwordx4 v[64:67], v3, s[4:7], s54 offen offset:0 sc1
v_mfma_f32_16x16x32_bf16 v[20:23], v[132:135], v[96:99], v[20:23]
ds_read_b64_tr_b16 v[148:149], v165 offset:36864
ds_read_b64_tr_b16 v[150:151], v165 offset:37888
s_waitcnt lgkmcnt(4)
v_mfma_f32_16x16x32_bf16 v[24:27], v[136:139], v[96:99], v[24:27]
ds_read_b64_tr_b16 v[152:153], v166 offset:36864
ds_read_b64_tr_b16 v[154:155], v166 offset:37888
buffer_load_dwordx4 v[68:71], v3, s[4:7], s54 offen offset:1024 sc1
v_mfma_f32_16x16x32_bf16 v[28:31], v[140:143], v[96:99], v[28:31]
ds_read_b64_tr_b16 v[156:157], v167 offset:36864
ds_read_b64_tr_b16 v[158:159], v167 offset:37888
s_waitcnt lgkmcnt(4)
v_mfma_f32_16x16x32_bf16 v[16:19], v[144:147], v[100:103], v[16:19]
ds_read_b64_tr_b16 v[128:129], v164 offset:40960
ds_read_b64_tr_b16 v[130:131], v164 offset:41984
buffer_load_dwordx4 v[72:75], v3, s[4:7], s54 offen offset:2048 sc1
v_mfma_f32_16x16x32_bf16 v[20:23], v[148:151], v[100:103], v[20:23]
ds_read_b64_tr_b16 v[132:133], v165 offset:40960
ds_read_b64_tr_b16 v[134:135], v165 offset:41984
s_waitcnt lgkmcnt(4)
v_mfma_f32_16x16x32_bf16 v[24:27], v[152:155], v[100:103], v[24:27]
ds_read_b64_tr_b16 v[136:137], v166 offset:40960
ds_read_b64_tr_b16 v[138:139], v166 offset:41984
buffer_load_dwordx4 v[76:79], v3, s[4:7], s54 offen offset:3072 sc1
s_add_u32 s54, s54, 4096
v_mfma_f32_16x16x32_bf16 v[28:31], v[156:159], v[100:103], v[28:31]
ds_read_b64_tr_b16 v[140:141], v167 offset:40960
ds_read_b64_tr_b16 v[142:143], v167 offset:41984
s_waitcnt lgkmcnt(4)
v_mfma_f32_16x16x32_bf16 v[16:19], v[128:131], v[104:107], v[16:19]
ds_read_b64_tr_b16 v[144:145], v164 offset:45056
ds_read_b64_tr_b16 v[146:147], v164 offset:46080
s_add_u32 m0, s55, 98304
    s_nop 0
buffer_load_dwordx4 v2, s[4:7], s58 offen offset:2048 sc1 lds
v_mfma_f32_16x16x32_bf16 v[20:23], v[132:135], v[104:107], v[20:23]
ds_read_b64_tr_b16 v[148:149], v165 offset:45056
ds_read_b64_tr_b16 v[150:151], v165 offset:46080
s_waitcnt lgkmcnt(4)
v_mfma_f32_16x16x32_bf16 v[24:27], v[136:139], v[104:107], v[24:27]
ds_read_b64_tr_b16 v[152:153], v166 offset:45056
ds_read_b64_tr_b16 v[154:155], v166 offset:46080
s_add_u32 m0, s55, 98304
    s_nop 0
buffer_load_dwordx4 v2, s[4:7], s58 offen offset:3072 sc1 lds
s_add_u32 s58, s58, 16384
v_mfma_f32_16x16x32_bf16 v[28:31], v[140:143], v[104:107], v[28:31]
ds_read_b64_tr_b16 v[156:157], v167 offset:45056
ds_read_b64_tr_b16 v[158:159], v167 offset:46080
s_waitcnt lgkmcnt(4)
v_mfma_f32_16x16x32_bf16 v[16:19], v[144:147], v[108:111], v[16:19]
buffer_load_dwordx4 v[240:243], v244, s[8:11], s56 offen
v_mfma_f32_16x16x32_bf16 v[20:23], v[148:151], v[108:111], v[20:23]
s_waitcnt lgkmcnt(0)
v_mfma_f32_16x16x32_bf16 v[24:27], v[152:155], v[108:111], v[24:27]
v_mfma_f32_16x16x32_bf16 v[28:31], v[156:159], v[108:111], v[28:31]
s_cmp_eq_u32 s49, 1
s_cbranch_scc1 L_g2_y1_38
    s_nop 4
ds_write_b128 v6, v[24:27] offset:0
ds_write_b128 v6, v[28:31] offset:1024
v_mov_b64 v[184:185], v[16:17]
v_mov_b64 v[186:187], v[18:19]
v_mov_b64 v[188:189], v[20:21]
v_mov_b64 v[190:191], v[22:23]
s_branch L_g2_yj_39
L_g2_y1_38:
    s_nop 0
ds_write_b128 v6, v[16:19] offset:0
    s_nop 0
ds_write_b128 v6, v[20:23] offset:1024
    s_nop 0
v_mov_b64 v[184:185], v[24:25]
v_mov_b64 v[186:187], v[26:27]
v_mov_b64 v[188:189], v[28:29]
v_mov_b64 v[190:191], v[30:31]
L_g2_yj_39:
s_waitcnt lgkmcnt(0)
s_waitcnt vmcnt(9)
s_barrier
ds_read_b128 v[128:131], v173 offset:0
ds_read_b128 v[132:135], v173 offset:1024
ds_read_b128 v[136:139], v173 offset:2048
ds_read_b128 v[140:143], v173 offset:3072
ds_read_b128 v[48:51], v7 offset:0
ds_read_b128 v[52:55], v7 offset:1024
s_waitcnt lgkmcnt(2)
v_mfma_f32_16x16x32_bf16 v[32:35], v[128:131], v[112:115], 0
ds_read_b128 v[144:147], v173 offset:4096
v_mfma_f32_16x16x32_bf16 v[36:39], v[132:135], v[112:115], 0
ds_read_b128 v[148:151], v173 offset:5120
s_waitcnt lgkmcnt(2)
v_mfma_f32_16x16x32_bf16 v[40:43], v[136:139], v[112:115], 0
ds_read_b128 v[152:155], v173 offset:6144
v_mfma_f32_16x16x32_bf16 v[44:47], v[140:143], v[112:115], 0
ds_read_b128 v[156:159], v173 offset:7168
s_waitcnt lgkmcnt(2)
v_mfma_f32_16x16x32_bf16 v[32:35], v[144:147], v[116:119], v[32:35]
ds_read_b128 v[128:131], v173 offset:8192
v_add_f32 v48, v48, v184
v_add_f32 v49, v49, v185
v_add_f32 v50, v50, v186
v_mfma_f32_16x16x32_bf16 v[36:39], v[148:151], v[116:119], v[36:39]
ds_read_b128 v[132:135], v173 offset:9216
v_add_f32 v51, v51, v187
v_add_f32 v52, v52, v188
v_add_f32 v53, v53, v189
s_waitcnt lgkmcnt(2)
v_mfma_f32_16x16x32_bf16 v[40:43], v[152:155], v[116:119], v[40:43]
ds_read_b128 v[136:139], v173 offset:10240
v_add_f32 v54, v54, v190
v_add_f32 v55, v55, v191
v_mul_f32 v192, 0xbfb8aa3b, v48
v_mfma_f32_16x16x32_bf16 v[44:47], v[156:159], v[116:119], v[44:47]
ds_read_b128 v[140:143], v173 offset:11264
v_mul_f32 v193, 0xbfb8aa3b, v49
v_mul_f32 v194, 0xbfb8aa3b, v50
v_mul_f32 v195, 0xbfb8aa3b, v51
s_waitcnt lgkmcnt(2)
v_mfma_f32_16x16x32_bf16 v[32:35], v[128:131], v[120:123], v[32:35]
ds_read_b128 v[144:147], v173 offset:12288
v_mul_f32 v196, 0xbfb8aa3b, v52
v_mul_f32 v197, 0xbfb8aa3b, v53
v_mul_f32 v198, 0xbfb8aa3b, v54
v_mfma_f32_16x16x32_bf16 v[36:39], v[132:135], v[120:123], v[36:39]
ds_read_b128 v[148:151], v173 offset:13312
v_mul_f32 v199, 0xbfb8aa3b, v55
v_exp_f32 v192, v192
v_exp_f32 v193, v193
s_waitcnt lgkmcnt(2)
v_mfma_f32_16x16x32_bf16 v[40:43], v[136:139], v[120:123], v[40:43]
ds_read_b128 v[152:155], v173 offset:14336
v_exp_f32 v194, v194
v_exp_f32 v195, v195
v_exp_f32 v196, v196
v_mfma_f32_16x16x32_bf16 v[44:47], v[140:143], v[120:123], v[44:47]
ds_read_b128 v[156:159], v173 offset:15360
v_exp_f32 v197, v197
v_exp_f32 v198, v198
v_exp_f32 v199, v199
s_waitcnt lgkmcnt(2)
v_mfma_f32_16x16x32_bf16 v[32:35], v[144:147], v[124:127], v[32:35]
v_add_f32 v192, 1.0, v192
v_add_f32 v193, 1.0, v193
v_add_f32 v194, 1.0, v194
v_mfma_f32_16x16x32_bf16 v[36:39], v[148:151], v[124:127], v[36:39]
v_add_f32 v195, 1.0, v195
v_add_f32 v196, 1.0, v196
v_add_f32 v197, 1.0, v197
s_waitcnt lgkmcnt(0)
v_mfma_f32_16x16x32_bf16 v[40:43], v[152:155], v[124:127], v[40:43]
v_add_f32 v198, 1.0, v198
v_add_f32 v199, 1.0, v199
v_rcp_f32 v192, v192
v_mfma_f32_16x16x32_bf16 v[44:47], v[156:159], v[124:127], v[44:47]
v_rcp_f32 v193, v193
v_rcp_f32 v194, v194
v_rcp_f32 v195, v195
s_waitcnt vmcnt(1)
s_barrier
ds_read_b128 v[128:131], v173 offset:32768
ds_read_b128 v[132:135], v173 offset:33792
ds_read_b128 v[136:139], v173 offset:34816
ds_read_b128 v[140:143], v173 offset:35840
s_waitcnt lgkmcnt(2)
v_mfma_f32_16x16x32_bf16 v[32:35], v[128:131], v[64:67], v[32:35]
ds_read_b128 v[144:147], v173 offset:36864
v_rcp_f32 v196, v196
v_rcp_f32 v197, v197
v_rcp_f32 v198, v198
v_mfma_f32_16x16x32_bf16 v[36:39], v[132:135], v[64:67], v[36:39]
ds_read_b128 v[148:151], v173 offset:37888
v_rcp_f32 v199, v199
v_mul_f32 v48, v48, v192
v_mul_f32 v49, v49, v193
s_waitcnt lgkmcnt(2)
v_mfma_f32_16x16x32_bf16 v[40:43], v[136:139], v[64:67], v[40:43]
ds_read_b128 v[152:155], v173 offset:38912
v_mul_f32 v50, v50, v194
v_mul_f32 v51, v51, v195
v_mul_f32 v52, v52, v196
v_mfma_f32_16x16x32_bf16 v[44:47], v[140:143], v[64:67], v[44:47]
ds_read_b128 v[156:159], v173 offset:39936
v_mul_f32 v53, v53, v197
v_mul_f32 v54, v54, v198
v_mul_f32 v55, v55, v199
s_waitcnt lgkmcnt(2)
v_mfma_f32_16x16x32_bf16 v[32:35], v[144:147], v[68:71], v[32:35]
ds_read_b128 v[128:131], v173 offset:40960
v_and_b32 v4, 15, v1
v_mul_u32_u24 v4, 144, v4
v_lshrrev_b32 v5, 4, v1
v_mfma_f32_16x16x32_bf16 v[36:39], v[148:151], v[68:71], v[36:39]
ds_read_b128 v[132:135], v173 offset:41984
v_lshl_add_u32 v4, v5, 3, v4
s_mul_i32 s60, s48, 2304
s_lshl_b32 s46, s49, 6
s_waitcnt lgkmcnt(2)
v_mfma_f32_16x16x32_bf16 v[40:43], v[152:155], v[68:71], v[40:43]
ds_read_b128 v[136:139], v173 offset:43008
s_add_u32 s60, s60, s46
s_add_u32 s60, s60, 0
v_add_u32 v4, s60, v4
v_mfma_f32_16x16x32_bf16 v[44:47], v[156:159], v[68:71], v[44:47]
ds_read_b128 v[140:143], v173 offset:44032
v_lshrrev_b32 v5, 3, v1
v_mul_u32_u24 v5, 144, v5
v_and_b32 v8, 7, v1
s_waitcnt lgkmcnt(2)
v_mfma_f32_16x16x32_bf16 v[32:35], v[128:131], v[72:75], v[32:35]
ds_read_b128 v[144:147], v173 offset:45056
v_lshl_add_u32 v5, v8, 4, v5
s_mul_i32 s60, s20, 1152
s_add_u32 s60, s60, 0
v_mfma_f32_16x16x32_bf16 v[36:39], v[132:135], v[72:75], v[36:39]
ds_read_b128 v[148:151], v173 offset:46080
v_add_u32 v5, s60, v5
s_waitcnt lgkmcnt(2)
v_mfma_f32_16x16x32_bf16 v[40:43], v[136:139], v[72:75], v[40:43]
ds_read_b128 v[152:155], v173 offset:47104
v_mfma_f32_16x16x32_bf16 v[44:47], v[140:143], v[72:75], v[44:47]
ds_read_b128 v[156:159], v173 offset:48128
s_waitcnt lgkmcnt(2)
v_mfma_f32_16x16x32_bf16 v[32:35], v[144:147], v[76:79], v[32:35]
v_mfma_f32_16x16x32_bf16 v[36:39], v[148:151], v[76:79], v[36:39]
s_waitcnt lgkmcnt(0)
v_mfma_f32_16x16x32_bf16 v[40:43], v[152:155], v[76:79], v[40:43]
v_mfma_f32_16x16x32_bf16 v[44:47], v[156:159], v[76:79], v[44:47]
s_cmp_eq_u32 s49, 1
s_cbranch_scc1 L_g2_k1_40
    s_nop 4
ds_write_b128 v6, v[40:43] offset:2048
ds_write_b128 v6, v[44:47] offset:3072
s_waitcnt lgkmcnt(0)
s_barrier
ds_read_b128 v[56:59], v7 offset:2048
ds_read_b128 v[60:63], v7 offset:3072
s_waitcnt lgkmcnt(0)
v_pk_add_f32 v[56:57], v[56:57], v[32:33]
v_pk_add_f32 v[58:59], v[58:59], v[34:35]
v_pk_add_f32 v[60:61], v[60:61], v[36:37]
v_pk_add_f32 v[62:63], v[62:63], v[38:39]
s_branch L_g2_j_41
L_g2_k1_40:
    s_nop 1
ds_write_b128 v6, v[32:35] offset:2048
ds_write_b128 v6, v[36:39] offset:3072
s_waitcnt lgkmcnt(0)
s_barrier
ds_read_b128 v[56:59], v7 offset:2048
ds_read_b128 v[60:63], v7 offset:3072
s_waitcnt lgkmcnt(0)
v_pk_add_f32 v[56:57], v[56:57], v[40:41]
v_pk_add_f32 v[58:59], v[58:59], v[42:43]
v_pk_add_f32 v[60:61], v[60:61], v[44:45]
v_pk_add_f32 v[62:63], v[62:63], v[46:47]
L_g2_j_41:
v_pk_mul_f32 v[56:57], v[56:57], v[48:49]
v_pk_mul_f32 v[58:59], v[58:59], v[50:51]
v_pk_mul_f32 v[60:61], v[60:61], v[52:53]
v_pk_mul_f32 v[62:63], v[62:63], v[54:55]
v_cvt_pk_bf16_f32 v8, v56, v57
v_cvt_pk_bf16_f32 v9, v58, v59
v_cvt_pk_bf16_f32 v10, v60, v61
v_cvt_pk_bf16_f32 v11, v62, v63
ds_write_b64 v4, v[8:9]
ds_write_b64 v4, v[10:11] offset:32
s_waitcnt vmcnt(0)
v_lshlrev_b32 v72, 16, v240
v_and_b32 v73, 0xffff0000, v240
v_lshlrev_b32 v74, 16, v241
v_and_b32 v75, 0xffff0000, v241
v_lshlrev_b32 v76, 16, v242
v_and_b32 v77, 0xffff0000, v242
v_lshlrev_b32 v78, 16, v243
v_and_b32 v79, 0xffff0000, v243
s_waitcnt lgkmcnt(0)
s_barrier
ds_read_b128 v[8:11], v5
s_waitcnt lgkmcnt(0)
v_lshlrev_b32 v64, 16, v8
v_and_b32 v65, 0xffff0000, v8
v_lshlrev_b32 v66, 16, v9
v_and_b32 v67, 0xffff0000, v9
v_lshlrev_b32 v68, 16, v10
v_and_b32 v69, 0xffff0000, v10
v_lshlrev_b32 v70, 16, v11
v_and_b32 v71, 0xffff0000, v11
v_pk_add_f32 v[72:73], v[72:73], v[64:65]
v_pk_add_f32 v[74:75], v[74:75], v[66:67]
v_pk_add_f32 v[76:77], v[76:77], v[68:69]
v_pk_add_f32 v[78:79], v[78:79], v[70:71]
v_cvt_pk_bf16_f32 v8, v72, v73
v_cvt_pk_bf16_f32 v9, v74, v75
v_cvt_pk_bf16_f32 v10, v76, v77
v_cvt_pk_bf16_f32 v11, v78, v79
buffer_store_dwordx4 v[8:11], v244, s[16:19], s56 offen
s_cmp_lg_u32 s21, 0
s_cbranch_scc1 L_ep_42
s_mov_b32 s57, 0
s_cmp_lg_u32 s20, 0
s_cbranch_scc1 L_fl_43
v_mov_b32 v16, s22
v_lshlrev_b32 v17, 2, v1
s_mov_b32 exec_hi, 0
buffer_store_dword v16, v17, s[4:7], s57 offen sc1
s_mov_b64 exec, -1
L_fl_43:
L_ep_42:
L_done:
s_endpgm
.section .rodata,"a"
.p2align 6
.amdhsa_kernel recurrent_scan__spectral_gfnet__geglu_ffn__prompt_kernel
  .amdhsa_next_free_vgpr 256
  .amdhsa_next_free_sgpr 102
  .amdhsa_accum_offset 256
  .amdhsa_group_segment_fixed_size 0
  .amdhsa_kernarg_size 80
  .amdhsa_user_sgpr_count 2
  .amdhsa_user_sgpr_kernarg_segment_ptr 1
  .amdhsa_system_sgpr_workgroup_id_x 1
.end_amdhsa_kernel
```
